```python
import torch

def _softmax(x, axis=-1):
    return torch.softmax(x, dim=axis)
def _gelu(x):
    return torch.nn.functional.gelu(x, approximate="tanh")
def _silu(x):
    return torch.nn.functional.silu(x)
def _sigmoid(x):
    return torch.sigmoid(x)
def _layernorm(x, axis=-1, eps=1e-5):
    m = x.mean(dim=axis, keepdim=True)
    v = x.var(dim=axis, keepdim=True, unbiased=False)
    return (x - m) / torch.sqrt(v + eps)
def _scatter_add(tgt, idx, src, axis=0):
    return tgt.clone().index_add_(axis, idx, src)
def _segment_sum(src, seg, n):
    out = torch.zeros((n,) + src.shape[1:], dtype=src.dtype)
    return out.index_add_(0, seg, src)
def _pad(x, pw):
    flat = tuple(v for pair in reversed(pw) for v in pair)
    return torch.nn.functional.pad(x, flat)

kernel_name = 'standalone__gqa_softmax__near_ridge'

def setup_inputs():

    _w = (lambda a: (lambda t: t.to(torch.bfloat16) if t.is_floating_point() else t)(torch.as_tensor(a)))
    B, Hq, Hkv, Sq, Sk, D = 8, 32, 8, 144, 1024, 128
    return {
        "q": _w((lambda *s: torch.randn(*s, dtype=torch.bfloat16) * 0.8)(B, Hq, Sq, D)),
        "k": _w((lambda *s: torch.randn(*s, dtype=torch.bfloat16) * 0.8)(B, Hkv, Sk, D)),
        "v": _w((lambda *s: torch.randn(*s, dtype=torch.bfloat16) * 0.05)(B, Hkv, Sk, D)),
    }

def reference(q, k, v):
    B, Hq, Sq, D = q.shape
    Hkv = k.shape[1]
    rep = Hq // Hkv
    k = (lambda x, n, axis: torch.repeat_interleave(x, n, dim=axis))(k, rep, axis=1)
    v = (lambda x, n, axis: torch.repeat_interleave(x, n, dim=axis))(v, rep, axis=1)
    scale = D ** -0.5
    scores = torch.einsum("bhqd,bhkd->bhqk", q, k) * scale
    p = _softmax(scores, axis=-1)
    return torch.einsum("bhqk,bhkd->bhqd", p, v)
```

```asm
; @launch grid=(256,1,1) block=(512,1,1) lds=143360
.amdgcn_target "amdgcn-amd-amdhsa--gfx950"
.text
.globl standalone__gqa_softmax__near_ridge_kernel
.p2align 8
.type standalone__gqa_softmax__near_ridge_kernel,@function
standalone__gqa_softmax__near_ridge_kernel:
    s_cmp_ge_u32 s2, 256
    s_cbranch_scc1 L_end
    s_load_dwordx4 s[48:51], s[0:1], 0
    s_load_dwordx4 s[52:55], s[0:1], 16
    v_lshrrev_b32 v1, 6, v0
    v_and_b32 v0, 63, v0
    v_readfirstlane_b32 s20, v1
    s_and_b32 s56, s2, 7
    s_lshr_b32 s57, s2, 3
    s_lshr_b32 s58, s57, 2
    s_lshl_b32 s56, s56, 3
    s_add_u32 s56, s56, s58
    s_and_b32 s57, s57, 3
    s_lshl_b32 s58, s56, 2
    s_add_u32 s57, s57, s58
    s_lshl_b32 s56, s56, 18
    s_mul_i32 s57, s57, 36864
    s_lshr_b32 s26, s56, 18
    s_mul_i32 s26, s26, 1
    s_and_b32 s26, s26, 15
    s_lshl_b32 s26, s26, 14
    s_and_b32 s58, s20, 3
    s_lshr_b32 s59, s20, 2
    v_lshrrev_b32 v3, 5, v0
    v_bfe_u32 v4, v0, 2, 2
    v_and_b32 v5, 3, v0
    v_lshrrev_b32 v6, 4, v0
    v_lshlrev_b32 v150, 4, v0
    s_lshl_b32 s40, s58, 10
    v_xor_b32 v8, s58, v5
    v_lshl_or_b32 v8, v6, 2, v8
    v_lshlrev_b32 v8, 4, v8
    v_lshl_or_b32 v8, v4, 8, v8
    v_add_u32 v151, s40, v8
    s_waitcnt lgkmcnt(0)
    s_add_u32 s12, s48, s57
    s_addc_u32 s13, s49, 0
    s_and_b32 s13, s13, 0xffff
    s_mov_b32 s14, 36864
    s_mov_b32 s15, 0x20000
    s_cmp_eq_u32 s59, 0
    s_cbranch_scc1 L_noremq
    s_lshl_b32 s46, s58, 2
    v_add_u32 v8, s46, v6
    v_lshlrev_b32 v8, 4, v8
    v_and_b32 v9, 15, v0
    v_add_u32 v9, 128, v9
    v_lshl_or_b32 v8, v9, 8, v8
    buffer_load_dwordx4 v[112:115], v8, s[12:15], 0 offen nt
L_noremq:
    s_lshl_b32 s46, s59, 14
    s_add_u32 s47, s46, s40
    s_add_u32 m0, s47, 0x8000
    s_add_u32 s44, s46, 0x0
    buffer_load_dwordx4 v151, s[12:15], s44 offen nt lds
    s_add_u32 m0, s47, 0x9000
    s_add_u32 s44, s46, 0x1000
    buffer_load_dwordx4 v151, s[12:15], s44 offen nt lds
    s_add_u32 m0, s47, 0xa000
    s_add_u32 s44, s46, 0x2000
    buffer_load_dwordx4 v151, s[12:15], s44 offen nt lds
    s_add_u32 m0, s47, 0xb000
    s_add_u32 s44, s46, 0x3000
    buffer_load_dwordx4 v151, s[12:15], s44 offen nt lds
    s_add_u32 s4, s50, s56
    s_addc_u32 s5, s51, 0
    s_and_b32 s5, s5, 0xffff
    s_mov_b32 s6, 262144
    s_mov_b32 s7, 0x20000
    s_lshl_b32 s46, s59, 13
    s_add_u32 s47, s46, s40
    s_add_u32 s27, s46, s26
    s_add_u32 m0, s47, 0x10000
    s_add_u32 s44, s27, 0x0
    buffer_load_dwordx4 v151, s[4:7], s44 offen nt lds
    s_add_u32 m0, s47, 0x11000
    s_add_u32 s44, s27, 0x1000
    buffer_load_dwordx4 v151, s[4:7], s44 offen nt lds
    s_add_u32 s8, s52, s56
    s_addc_u32 s9, s53, 0
    s_and_b32 s9, s9, 0xffff
    s_mov_b32 s10, 262144
    s_mov_b32 s11, 0x20000
    s_and_b32 s45, s58, 1
    s_lshl_b32 s45, s45, 1
    v_xor_b32 v8, s45, v5
    v_lshl_or_b32 v8, v6, 2, v8
    v_lshlrev_b32 v8, 4, v8
    v_lshl_or_b32 v8, v4, 8, v8
    v_add_u32 v152, s40, v8
    s_add_u32 s16, s54, s57
    s_addc_u32 s17, s55, 0
    s_and_b32 s17, s17, 0xffff
    s_mov_b32 s18, 36864
    s_mov_b32 s19, 0x20000
    v_bfe_u32 v8, v0, 2, 3
    s_lshl_b32 s47, s59, 3
    v_add_u32 v8, s47, v8
    v_lshlrev_b32 v8, 10, v8
    v_lshl_or_b32 v8, v5, 6, v8
    v_xor_b32 v9, v3, v4
    v_lshl_or_b32 v8, v9, 4, v8
    v_add_u32 v144, 0x10000, v8
    v_xor_b32 v145, 32, v144
    v_add_u32 v8, s47, v3
    v_lshlrev_b32 v8, 10, v8
    v_lshl_or_b32 v8, v4, 6, v8
    v_and_b32 v9, 1, v6
    v_xor_b32 v9, v9, v3
    v_lshl_or_b32 v8, v9, 5, v8
    v_lshl_or_b32 v146, v5, 3, v8
    s_sub_u32 s46, s58, s59
    s_lshl_b32 s46, s46, 13
    s_add_u32 s46, s46, 0xffff8000
    v_add_u32 v132, s46, v144
    v_add_u32 v133, s46, v145
    s_mov_b32 s22, 0x3e0293ee
    s_mov_b32 s23, 0x3e0293ee
    s_mov_b32 s28, 0
    s_mov_b32 s29, 0
    s_mov_b32 s21, 3
    s_getpc_b64 s[38:39]
L_pc:
    s_add_u32 s34, s38, L_rare_m0-L_pc
    s_addc_u32 s35, s39, 0
    s_add_u32 s36, s38, L_rare_m1-L_pc
    s_addc_u32 s37, s39, 0
    s_add_u32 s38, s38, L_rare_r-L_pc
    s_addc_u32 s39, s39, 0
    v_mov_b32 v48, 0
    v_mov_b32 v49, 0
    v_mov_b32 v50, 0
    v_mov_b32 v51, 0
    v_mov_b32 v52, 0
    v_mov_b32 v53, 0
    v_mov_b32 v54, 0
    v_mov_b32 v55, 0
    v_mov_b32 v56, 0
    v_mov_b32 v57, 0
    v_mov_b32 v58, 0
    v_mov_b32 v59, 0
    v_mov_b32 v60, 0
    v_mov_b32 v61, 0
    v_mov_b32 v62, 0
    v_mov_b32 v63, 0
    v_mov_b32 v64, 0
    v_mov_b32 v65, 0
    v_mov_b32 v66, 0
    v_mov_b32 v67, 0
    v_mov_b32 v68, 0
    v_mov_b32 v69, 0
    v_mov_b32 v70, 0
    v_mov_b32 v71, 0
    v_mov_b32 v72, 0
    v_mov_b32 v73, 0
    v_mov_b32 v74, 0
    v_mov_b32 v75, 0
    v_mov_b32 v76, 0
    v_mov_b32 v77, 0
    v_mov_b32 v78, 0
    v_mov_b32 v79, 0
    v_mov_b32 v80, 0
    v_mov_b32 v81, 0
    v_mov_b32 v82, 0
    v_mov_b32 v83, 0
    v_mov_b32 v84, 0
    v_mov_b32 v85, 0
    v_mov_b32 v86, 0
    v_mov_b32 v87, 0
    v_mov_b32 v88, 0
    v_mov_b32 v89, 0
    v_mov_b32 v90, 0
    v_mov_b32 v91, 0
    v_mov_b32 v92, 0
    v_mov_b32 v93, 0
    v_mov_b32 v94, 0
    v_mov_b32 v95, 0
    v_mov_b32 v96, 0
    v_mov_b32 v97, 0
    v_mov_b32 v98, 0
    v_mov_b32 v99, 0
    v_mov_b32 v100, 0
    v_mov_b32 v101, 0
    v_mov_b32 v102, 0
    v_mov_b32 v103, 0
    v_mov_b32 v104, 0
    v_mov_b32 v105, 0
    v_mov_b32 v106, 0
    v_mov_b32 v107, 0
    v_mov_b32 v108, 0
    v_mov_b32 v109, 0
    v_mov_b32 v110, 0
    v_mov_b32 v111, 0
    v_mov_b32 v140, 0
    v_mov_b32 v142, 0
    s_lshl_b32 s43, s59, 13
    s_add_u32 s42, s43, s40
    s_add_u32 s27, s26, 0x4000
    s_and_b32 s27, s27, 0x3ffff
    s_add_u32 s27, s27, s43
    s_add_u32 m0, s42, 0x14000
    s_add_u32 s44, s27, 0x0
    buffer_load_dwordx4 v151, s[4:7], s44 offen nt lds
    s_add_u32 m0, s42, 0x15000
    s_add_u32 s44, s27, 0x1000
    buffer_load_dwordx4 v151, s[4:7], s44 offen nt lds
    s_add_u32 s27, s26, 0x0
    s_and_b32 s27, s27, 0x3ffff
    s_add_u32 s27, s27, s43
    s_add_u32 m0, s42, 0x0
    s_add_u32 s44, s27, 0x0
    buffer_load_dwordx4 v152, s[8:11], s44 offen nt lds
    s_add_u32 m0, s42, 0x1000
    s_add_u32 s44, s27, 0x1000
    buffer_load_dwordx4 v152, s[8:11], s44 offen nt lds
    s_add_u32 s27, s26, 0x8000
    s_and_b32 s27, s27, 0x3ffff
    s_add_u32 s27, s27, s43
    s_add_u32 m0, s42, 0x18000
    s_add_u32 s44, s27, 0x0
    buffer_load_dwordx4 v151, s[4:7], s44 offen nt lds
    s_add_u32 m0, s42, 0x19000
    s_add_u32 s44, s27, 0x1000
    buffer_load_dwordx4 v151, s[4:7], s44 offen nt lds
    s_cmp_eq_u32 s59, 0
    s_cbranch_scc1 L_role0
    s_cmp_lt_u32 s20, 6
    s_cbranch_scc1 L_role1
    s_branch L_role2
    s_nop 0
L_role0:
    s_waitcnt vmcnt(6) lgkmcnt(0)
    s_barrier
    ds_read_b128 v[156:159], v132 offset:0
    ds_read_b128 v[160:163], v133 offset:0
    ds_read_b128 v[164:167], v132 offset:256
    ds_read_b128 a[0:3], v144 offset:0
    s_waitcnt lgkmcnt(3)
    v_lshlrev_b32 v16, 16, v156
    v_and_b32 v17, 0xffff0000, v156
    v_lshlrev_b32 v18, 16, v157
    v_and_b32 v19, 0xffff0000, v157
    v_lshlrev_b32 v20, 16, v158
    v_and_b32 v21, 0xffff0000, v158
    v_lshlrev_b32 v22, 16, v159
    v_and_b32 v23, 0xffff0000, v159
    v_mul_f32 v16, s22, v16
    v_mul_f32 v17, s22, v17
    v_mul_f32 v18, s22, v18
    v_mul_f32 v19, s22, v19
    v_mul_f32 v20, s22, v20
    v_mul_f32 v21, s22, v21
    v_mul_f32 v22, s22, v22
    v_mul_f32 v23, s22, v23
    v_cvt_pk_bf16_f32 v156, v16, v17
    v_cvt_pk_bf16_f32 v157, v18, v19
    v_cvt_pk_bf16_f32 v158, v20, v21
    v_cvt_pk_bf16_f32 v159, v22, v23
    s_waitcnt lgkmcnt(0)
    s_nop 0
    v_mfma_f32_32x32x16_bf16 v[0:15], a[0:3], v[156:159], 0
    ds_read_b128 v[168:171], v133 offset:256
    ds_read_b128 a[4:7], v145 offset:0
    v_lshlrev_b32 v24, 16, v160
    v_and_b32 v25, 0xffff0000, v160
    v_lshlrev_b32 v26, 16, v161
    v_and_b32 v27, 0xffff0000, v161
    v_lshlrev_b32 v28, 16, v162
    v_and_b32 v29, 0xffff0000, v162
    v_lshlrev_b32 v30, 16, v163
    v_and_b32 v31, 0xffff0000, v163
    v_mul_f32 v24, s22, v24
    v_mul_f32 v25, s22, v25
    v_mul_f32 v26, s22, v26
    v_mul_f32 v27, s22, v27
    v_mul_f32 v28, s22, v28
    v_mul_f32 v29, s22, v29
    v_mul_f32 v30, s22, v30
    v_mul_f32 v31, s22, v31
    v_cvt_pk_bf16_f32 v160, v24, v25
    v_cvt_pk_bf16_f32 v161, v26, v27
    v_cvt_pk_bf16_f32 v162, v28, v29
    v_cvt_pk_bf16_f32 v163, v30, v31
    ds_read_b128 v[172:175], v132 offset:512
    s_waitcnt lgkmcnt(1)
    v_mfma_f32_32x32x16_bf16 v[0:15], a[4:7], v[160:163], v[0:15]
    ds_read_b128 a[8:11], v144 offset:256
    v_lshlrev_b32 v16, 16, v164
    v_and_b32 v17, 0xffff0000, v164
    v_lshlrev_b32 v18, 16, v165
    v_and_b32 v19, 0xffff0000, v165
    v_lshlrev_b32 v20, 16, v166
    v_and_b32 v21, 0xffff0000, v166
    v_lshlrev_b32 v22, 16, v167
    v_and_b32 v23, 0xffff0000, v167
    v_mul_f32 v16, s22, v16
    v_mul_f32 v17, s22, v17
    v_mul_f32 v18, s22, v18
    v_mul_f32 v19, s22, v19
    v_mul_f32 v20, s22, v20
    v_mul_f32 v21, s22, v21
    v_mul_f32 v22, s22, v22
    v_mul_f32 v23, s22, v23
    v_cvt_pk_bf16_f32 v164, v16, v17
    v_cvt_pk_bf16_f32 v165, v18, v19
    v_cvt_pk_bf16_f32 v166, v20, v21
    v_cvt_pk_bf16_f32 v167, v22, v23
    ds_read_b128 v[176:179], v133 offset:512
    ds_read_b128 v[180:183], v132 offset:768
    s_add_u32 s27, s26, 0x4000
    s_and_b32 s27, s27, 0x3ffff
    s_add_u32 s27, s27, s43
    s_add_u32 m0, s42, 0x4000
    s_add_u32 s44, s27, 0x0
    buffer_load_dwordx4 v152, s[8:11], s44 offen nt lds
    s_waitcnt lgkmcnt(2)
    v_mfma_f32_32x32x16_bf16 v[0:15], a[8:11], v[164:167], v[0:15]
    ds_read_b128 a[12:15], v145 offset:256
    v_lshlrev_b32 v24, 16, v168
    v_and_b32 v25, 0xffff0000, v168
    v_lshlrev_b32 v26, 16, v169
    v_and_b32 v27, 0xffff0000, v169
    v_lshlrev_b32 v28, 16, v170
    v_and_b32 v29, 0xffff0000, v170
    v_lshlrev_b32 v30, 16, v171
    v_and_b32 v31, 0xffff0000, v171
    v_mul_f32 v24, s22, v24
    v_mul_f32 v25, s22, v25
    v_mul_f32 v26, s22, v26
    v_mul_f32 v27, s22, v27
    v_mul_f32 v28, s22, v28
    v_mul_f32 v29, s22, v29
    v_mul_f32 v30, s22, v30
    v_mul_f32 v31, s22, v31
    v_cvt_pk_bf16_f32 v168, v24, v25
    v_cvt_pk_bf16_f32 v169, v26, v27
    v_cvt_pk_bf16_f32 v170, v28, v29
    v_cvt_pk_bf16_f32 v171, v30, v31
    ds_read_b128 v[184:187], v133 offset:768
    ds_read_b128 a[16:19], v144 offset:512
    s_waitcnt lgkmcnt(2)
    v_mfma_f32_32x32x16_bf16 v[0:15], a[12:15], v[168:171], v[0:15]
    v_lshlrev_b32 v16, 16, v172
    v_and_b32 v17, 0xffff0000, v172
    v_lshlrev_b32 v18, 16, v173
    v_and_b32 v19, 0xffff0000, v173
    v_lshlrev_b32 v20, 16, v174
    v_and_b32 v21, 0xffff0000, v174
    v_lshlrev_b32 v22, 16, v175
    v_and_b32 v23, 0xffff0000, v175
    v_mul_f32 v16, s22, v16
    v_mul_f32 v17, s22, v17
    v_mul_f32 v18, s22, v18
    v_mul_f32 v19, s22, v19
    v_mul_f32 v20, s22, v20
    v_mul_f32 v21, s22, v21
    v_mul_f32 v22, s22, v22
    v_mul_f32 v23, s22, v23
    v_cvt_pk_bf16_f32 v172, v16, v17
    v_cvt_pk_bf16_f32 v173, v18, v19
    v_cvt_pk_bf16_f32 v174, v20, v21
    v_cvt_pk_bf16_f32 v175, v22, v23
    ds_read_b128 a[20:23], v145 offset:512
    ds_read_b128 a[24:27], v144 offset:768
    ds_read_b128 a[28:31], v145 offset:768
    v_lshlrev_b32 v24, 16, v176
    v_and_b32 v25, 0xffff0000, v176
    v_lshlrev_b32 v26, 16, v177
    v_and_b32 v27, 0xffff0000, v177
    v_lshlrev_b32 v28, 16, v178
    v_and_b32 v29, 0xffff0000, v178
    v_lshlrev_b32 v30, 16, v179
    v_and_b32 v31, 0xffff0000, v179
    v_mul_f32 v24, s22, v24
    v_mul_f32 v25, s22, v25
    v_mul_f32 v26, s22, v26
    v_mul_f32 v27, s22, v27
    v_mul_f32 v28, s22, v28
    v_mul_f32 v29, s22, v29
    v_mul_f32 v30, s22, v30
    v_mul_f32 v31, s22, v31
    v_cvt_pk_bf16_f32 v176, v24, v25
    v_cvt_pk_bf16_f32 v177, v26, v27
    v_cvt_pk_bf16_f32 v178, v28, v29
    v_cvt_pk_bf16_f32 v179, v30, v31
    s_add_u32 m0, s42, 0x5000
    s_add_u32 s44, s27, 0x1000
    buffer_load_dwordx4 v152, s[8:11], s44 offen nt lds
    s_waitcnt lgkmcnt(0)
    v_mfma_f32_32x32x16_bf16 v[0:15], a[16:19], v[172:175], v[0:15]
    v_lshlrev_b32 v16, 16, v180
    v_and_b32 v17, 0xffff0000, v180
    v_lshlrev_b32 v18, 16, v181
    v_and_b32 v19, 0xffff0000, v181
    v_lshlrev_b32 v20, 16, v182
    v_and_b32 v21, 0xffff0000, v182
    v_lshlrev_b32 v22, 16, v183
    v_and_b32 v23, 0xffff0000, v183
    v_mul_f32 v16, s22, v16
    v_mul_f32 v17, s22, v17
    v_mul_f32 v18, s22, v18
    v_mul_f32 v19, s22, v19
    v_mul_f32 v20, s22, v20
    v_mul_f32 v21, s22, v21
    v_mul_f32 v22, s22, v22
    v_mul_f32 v23, s22, v23
    v_cvt_pk_bf16_f32 v180, v16, v17
    v_cvt_pk_bf16_f32 v181, v18, v19
    v_cvt_pk_bf16_f32 v182, v20, v21
    v_cvt_pk_bf16_f32 v183, v22, v23
    v_mfma_f32_32x32x16_bf16 v[0:15], a[20:23], v[176:179], v[0:15]
    s_add_u32 s27, s26, 0xc000
    s_and_b32 s27, s27, 0x3ffff
    s_add_u32 s27, s27, s43
    s_add_u32 m0, s42, 0x1c000
    s_add_u32 s44, s27, 0x0
    buffer_load_dwordx4 v151, s[4:7], s44 offen nt lds
    s_add_u32 m0, s42, 0x1d000
    s_add_u32 s44, s27, 0x1000
    buffer_load_dwordx4 v151, s[4:7], s44 offen nt lds
    v_lshlrev_b32 v24, 16, v184
    v_and_b32 v25, 0xffff0000, v184
    v_lshlrev_b32 v26, 16, v185
    v_and_b32 v27, 0xffff0000, v185
    v_lshlrev_b32 v28, 16, v186
    v_and_b32 v29, 0xffff0000, v186
    v_lshlrev_b32 v30, 16, v187
    v_and_b32 v31, 0xffff0000, v187
    v_mul_f32 v24, s22, v24
    v_mul_f32 v25, s22, v25
    v_mul_f32 v26, s22, v26
    v_mul_f32 v27, s22, v27
    v_mul_f32 v28, s22, v28
    v_mul_f32 v29, s22, v29
    v_mul_f32 v30, s22, v30
    v_mul_f32 v31, s22, v31
    v_cvt_pk_bf16_f32 v184, v24, v25
    v_cvt_pk_bf16_f32 v185, v26, v27
    v_cvt_pk_bf16_f32 v186, v28, v29
    v_cvt_pk_bf16_f32 v187, v30, v31
    v_mfma_f32_32x32x16_bf16 v[0:15], a[24:27], v[180:183], v[0:15]
    s_nop 0
    v_mfma_f32_32x32x16_bf16 v[0:15], a[28:31], v[184:187], v[0:15]
    s_nop 11
    v_max3_f32 v134, v0, v1, v2
    v_max3_f32 v134, v134, v3, v4
    v_max3_f32 v134, v134, v5, v6
    v_max3_f32 v134, v134, v7, v8
    v_max3_f32 v134, v134, v9, v10
    v_max3_f32 v134, v134, v11, v12
    v_max3_f32 v134, v134, v13, v14
    v_max_f32 v134, v134, v15
    v_mov_b32 v135, v134
    s_nop 1
    v_permlane32_swap_b32 v134, v135
    v_max_f32 v134, v134, v135
    v_sub_f32 v0, v0, v134
    v_sub_f32 v1, v1, v134
    v_sub_f32 v2, v2, v134
    v_sub_f32 v3, v3, v134
    v_sub_f32 v4, v4, v134
    v_sub_f32 v5, v5, v134
    v_sub_f32 v6, v6, v134
    v_sub_f32 v7, v7, v134
    v_sub_f32 v8, v8, v134
    v_sub_f32 v9, v9, v134
    v_sub_f32 v10, v10, v134
    v_sub_f32 v11, v11, v134
    v_sub_f32 v12, v12, v134
    v_sub_f32 v13, v13, v134
    v_sub_f32 v14, v14, v134
    v_sub_f32 v15, v15, v134
    v_sub_f32 v32, 0, v134
    v_sub_f32 v33, 0, v134
    v_sub_f32 v34, 0, v134
    v_sub_f32 v35, 0, v134
    v_sub_f32 v36, 0, v134
    v_sub_f32 v37, 0, v134
    v_sub_f32 v38, 0, v134
    v_sub_f32 v39, 0, v134
    v_sub_f32 v40, 0, v134
    v_sub_f32 v41, 0, v134
    v_sub_f32 v42, 0, v134
    v_sub_f32 v43, 0, v134
    v_sub_f32 v44, 0, v134
    v_sub_f32 v45, 0, v134
    v_sub_f32 v46, 0, v134
    v_sub_f32 v47, 0, v134
    v_exp_f32 v132, v0
    v_exp_f32 v133, v1
    s_nop 0
    v_add_f32 v141, v132, v133
    v_cvt_pk_bf16_f32 v112, v132, v133
    v_exp_f32 v134, v2
    v_exp_f32 v135, v3
    v_add_f32 v141, v141, v134
    v_add_f32 v141, v141, v135
    v_cvt_pk_bf16_f32 v113, v134, v135
    v_exp_f32 v132, v4
    v_exp_f32 v133, v5
    v_add_f32 v141, v141, v132
    v_add_f32 v141, v141, v133
    v_cvt_pk_bf16_f32 v114, v132, v133
    v_exp_f32 v134, v6
    v_exp_f32 v135, v7
    v_add_f32 v141, v141, v134
    v_add_f32 v141, v141, v135
    v_cvt_pk_bf16_f32 v115, v134, v135
    s_waitcnt vmcnt(4)
    s_barrier
    ds_read_b128 a[0:3], v144 offset:16384
    s_waitcnt lgkmcnt(0)
    v_mfma_f32_32x32x16_bf16 v[16:31], a[0:3], v[156:159], v[32:47]
    ds_read_b128 a[4:7], v145 offset:16384
    ds_read_b128 a[8:11], v144 offset:16640
    ds_read_b128 a[12:15], v145 offset:16640
    v_exp_f32 v132, v8
    v_exp_f32 v133, v9
    s_add_u32 s27, s26, 0x8000
    s_and_b32 s27, s27, 0x3ffff
    s_add_u32 m0, s40, 0x8000
    s_add_u32 s44, s27, 0x0
    buffer_load_dwordx4 v152, s[8:11], s44 offen nt lds
    s_waitcnt lgkmcnt(2)
    v_mfma_f32_32x32x16_bf16 v[16:31], a[4:7], v[160:163], v[16:31]
    ds_read_b128 a[16:19], v144 offset:16896
    ds_read_b128 a[20:23], v145 offset:16896
    ds_read_b128 a[24:27], v144 offset:17152
    v_add_f32 v141, v141, v132
    v_add_f32 v141, v141, v133
    v_cvt_pk_bf16_f32 v116, v132, v133
    s_waitcnt lgkmcnt(3)
    v_mfma_f32_32x32x16_bf16 v[16:31], a[8:11], v[164:167], v[16:31]
    ds_read_b128 a[28:31], v145 offset:17152
    v_exp_f32 v134, v10
    v_exp_f32 v135, v11
    v_add_f32 v141, v141, v134
    s_add_u32 m0, s40, 0x9000
    s_add_u32 s44, s27, 0x1000
    buffer_load_dwordx4 v152, s[8:11], s44 offen nt lds
    v_mfma_f32_32x32x16_bf16 v[16:31], a[12:15], v[168:171], v[16:31]
    v_add_f32 v141, v141, v135
    v_cvt_pk_bf16_f32 v117, v134, v135
    v_exp_f32 v132, v12
    s_add_u32 m0, s40, 0xa000
    s_add_u32 s44, s27, 0x2000
    buffer_load_dwordx4 v152, s[8:11], s44 offen nt lds
    s_waitcnt lgkmcnt(0)
    v_mfma_f32_32x32x16_bf16 v[16:31], a[16:19], v[172:175], v[16:31]
    ds_read_b64_tr_b16 a[0:1], v146 offset:0
    ds_read_b64_tr_b16 a[2:3], v146 offset:2048
    v_exp_f32 v133, v13
    v_add_f32 v141, v141, v132
    s_add_u32 m0, s40, 0xb000
    s_add_u32 s44, s27, 0x3000
    buffer_load_dwordx4 v152, s[8:11], s44 offen nt lds
    v_mfma_f32_32x32x16_bf16 v[16:31], a[20:23], v[176:179], v[16:31]
    ds_read_b64_tr_b16 a[4:5], v146 offset:256
    ds_read_b64_tr_b16 a[6:7], v146 offset:2304
    v_add_f32 v141, v141, v133
    v_cvt_pk_bf16_f32 v118, v132, v133
    v_exp_f32 v134, v14
    s_add_u32 s27, s26, 0x10000
    s_and_b32 s27, s27, 0x3ffff
    s_add_u32 m0, s40, 0x10000
    s_add_u32 s44, s27, 0x0
    buffer_load_dwordx4 v151, s[4:7], s44 offen nt lds
    v_mfma_f32_32x32x16_bf16 v[16:31], a[24:27], v[180:183], v[16:31]
    ds_read_b64_tr_b16 a[8:9], v146 offset:512
    ds_read_b64_tr_b16 a[10:11], v146 offset:2560
    v_exp_f32 v135, v15
    v_add_f32 v141, v141, v134
    v_add_f32 v141, v141, v135
    v_mfma_f32_32x32x16_bf16 v[16:31], a[28:31], v[184:187], v[16:31]
    v_cvt_pk_bf16_f32 v119, v134, v135
    v_cmp_nge_f32 vcc, 0x44800000, v141
    ds_read_b64_tr_b16 a[12:13], v146 offset:768
    ds_read_b64_tr_b16 a[14:15], v146 offset:2816
    s_add_u32 m0, s40, 0x11000
    s_add_u32 s44, s27, 0x1000
    buffer_load_dwordx4 v151, s[4:7], s44 offen nt lds
    s_cbranch_vccnz L_rc_1
L_rb_2:
    v_add_f32 v140, v140, v141
    ds_read_b64_tr_b16 a[16:17], v146 offset:4096
    ds_read_b64_tr_b16 a[18:19], v146 offset:6144
    s_waitcnt lgkmcnt(4)
    v_mfma_f32_32x32x16_bf16 v[48:63], a[0:3], v[112:115], v[48:63]
    ds_read_b64_tr_b16 a[20:21], v146 offset:4352
    ds_read_b64_tr_b16 a[22:23], v146 offset:6400
    v_exp_f32 v132, v16
    v_exp_f32 v133, v17
    s_nop 0
    v_add_f32 v141, v132, v133
    s_add_u32 m0, s40, 0x12000
    s_add_u32 s44, s27, 0x2000
    buffer_load_dwordx4 v151, s[4:7], s44 offen nt lds
    v_mfma_f32_32x32x16_bf16 v[64:79], a[4:7], v[112:115], v[64:79]
    ds_read_b64_tr_b16 a[24:25], v146 offset:4608
    ds_read_b64_tr_b16 a[26:27], v146 offset:6656
    s_add_u32 m0, s40, 0x13000
    s_add_u32 s44, s27, 0x3000
    buffer_load_dwordx4 v151, s[4:7], s44 offen nt lds
    v_mfma_f32_32x32x16_bf16 v[80:95], a[8:11], v[112:115], v[80:95]
    ds_read_b64_tr_b16 a[28:29], v146 offset:4864
    ds_read_b64_tr_b16 a[30:31], v146 offset:6912
    s_add_u32 s27, s26, 0xc000
    s_and_b32 s27, s27, 0x3ffff
    s_add_u32 m0, s40, 0xc000
    s_add_u32 s44, s27, 0x0
    buffer_load_dwordx4 v152, s[8:11], s44 offen nt lds
    s_waitcnt lgkmcnt(4)
    v_mfma_f32_32x32x16_bf16 v[96:111], a[12:15], v[112:115], v[96:111]
    ds_read_b128 a[0:3], v144 offset:32768
    v_cvt_pk_bf16_f32 v112, v132, v133
    v_exp_f32 v134, v18
    v_exp_f32 v135, v19
    v_add_f32 v141, v141, v134
    v_add_f32 v141, v141, v135
    v_cvt_pk_bf16_f32 v113, v134, v135
    v_exp_f32 v132, v20
    v_exp_f32 v133, v21
    v_add_f32 v141, v141, v132
    v_mfma_f32_32x32x16_bf16 v[48:63], a[16:19], v[116:119], v[48:63]
    ds_read_b128 a[4:7], v145 offset:32768
    v_add_f32 v141, v141, v133
    v_cvt_pk_bf16_f32 v114, v132, v133
    v_exp_f32 v134, v22
    s_add_u32 m0, s40, 0xd000
    s_add_u32 s44, s27, 0x1000
    buffer_load_dwordx4 v152, s[8:11], s44 offen nt lds
    v_mfma_f32_32x32x16_bf16 v[64:79], a[20:23], v[116:119], v[64:79]
    ds_read_b128 a[8:11], v144 offset:33024
    v_exp_f32 v135, v23
    v_add_f32 v141, v141, v134
    s_add_u32 m0, s40, 0xe000
    s_add_u32 s44, s27, 0x2000
    buffer_load_dwordx4 v152, s[8:11], s44 offen nt lds
    s_waitcnt lgkmcnt(1)
    v_mfma_f32_32x32x16_bf16 v[80:95], a[24:27], v[116:119], v[80:95]
    ds_read_b128 a[12:15], v145 offset:33024
    v_add_f32 v141, v141, v135
    v_cvt_pk_bf16_f32 v115, v134, v135
    s_add_u32 m0, s40, 0xf000
    s_add_u32 s44, s27, 0x3000
    buffer_load_dwordx4 v152, s[8:11], s44 offen nt lds
    s_mov_b32 s41, 0x14000
    s_mov_b32 s43, 0x10000
    s_lshl_b32 s42, s58, 12
    s_lshl_b32 s44, s58, 4
    v_subrev_u32 v147, s40, v151
    v_xor_b32 v147, s44, v147
    v_add_u32 v147, s42, v147
    v_xor_b32 v148, 16, v147
    v_xor_b32 v149, 32, v147
    v_xor_b32 v143, 48, v147
    v_mfma_f32_32x32x16_bf16 v[96:111], a[28:31], v[116:119], v[96:111]
    s_waitcnt vmcnt(12)
    s_barrier
L_loop0:
    v_mfma_f32_32x32x16_bf16 v[0:15], a[0:3], v[156:159], v[32:47]
    ds_read_b128 a[16:19], v144 offset:33280
    ds_read_b128 a[20:23], v145 offset:33280
    v_exp_f32 v132, v24
    v_exp_f32 v133, v25
    s_waitcnt lgkmcnt(4)
    v_mfma_f32_32x32x16_bf16 v[0:15], a[4:7], v[160:163], v[0:15]
    ds_read_b128 a[24:27], v144 offset:33536
    v_add_f32 v141, v141, v132
    v_add_f32 v141, v141, v133
    v_cvt_pk_bf16_f32 v116, v132, v133
    s_waitcnt lgkmcnt(4)
    v_mfma_f32_32x32x16_bf16 v[0:15], a[8:11], v[164:167], v[0:15]
    ds_read_b128 a[28:31], v145 offset:33536
    v_exp_f32 v134, v26
    v_exp_f32 v135, v27
    s_add_u32 s27, s41, s26
    s_and_b32 s27, s27, 0x3ffff
    s_cmp_lt_u32 s41, 0x40000
    s_cselect_b32 s27, s27, 0x100000
    s_add_u32 m0, s42, 0x14000
    s_add_u32 s41, s41, 0x4000
    buffer_load_dwordx4 v147, s[4:7], s27 offen offset:0 nt lds
    s_waitcnt lgkmcnt(1)
    v_mfma_f32_32x32x16_bf16 v[0:15], a[12:15], v[168:171], v[0:15]
    v_add_f32 v141, v141, v134
    v_add_f32 v141, v141, v135
    v_cvt_pk_bf16_f32 v117, v134, v135
    v_mfma_f32_32x32x16_bf16 v[0:15], a[16:19], v[172:175], v[0:15]
    ds_read_b64_tr_b16 a[0:1], v146 offset:16384
    ds_read_b64_tr_b16 a[2:3], v146 offset:18432
    v_exp_f32 v132, v28
    v_exp_f32 v133, v29
    v_mfma_f32_32x32x16_bf16 v[0:15], a[20:23], v[176:179], v[0:15]
    ds_read_b64_tr_b16 a[4:5], v146 offset:16640
    ds_read_b64_tr_b16 a[6:7], v146 offset:18688
    v_add_f32 v141, v141, v132
    v_add_f32 v141, v141, v133
    v_cvt_pk_bf16_f32 v118, v132, v133
    buffer_load_dwordx4 v148, s[4:7], s27 offen offset:1024 nt lds
    v_mfma_f32_32x32x16_bf16 v[0:15], a[24:27], v[180:183], v[0:15]
    ds_read_b64_tr_b16 a[8:9], v146 offset:16896
    ds_read_b64_tr_b16 a[10:11], v146 offset:18944
    v_exp_f32 v134, v30
    v_exp_f32 v135, v31
    buffer_load_dwordx4 v149, s[4:7], s27 offen offset:2048 nt lds
    s_waitcnt lgkmcnt(4)
    v_mfma_f32_32x32x16_bf16 v[0:15], a[28:31], v[184:187], v[0:15]
    v_add_f32 v141, v141, v134
    v_add_f32 v141, v141, v135
    v_cvt_pk_bf16_f32 v119, v134, v135
    v_cmp_nge_f32 vcc, 0x44800000, v141
    ds_read_b64_tr_b16 a[12:13], v146 offset:17152
    ds_read_b64_tr_b16 a[14:15], v146 offset:19200
    buffer_load_dwordx4 v143, s[4:7], s27 offen offset:3072 nt lds
    s_cbranch_vccnz L_rc_11
L_rb_12:
    v_add_f32 v140, v140, v141
    ds_read_b64_tr_b16 a[16:17], v146 offset:20480
    ds_read_b64_tr_b16 a[18:19], v146 offset:22528
    v_mfma_f32_32x32x16_bf16 v[48:63], a[0:3], v[112:115], v[48:63]
    ds_read_b64_tr_b16 a[20:21], v146 offset:20736
    ds_read_b64_tr_b16 a[22:23], v146 offset:22784
    v_exp_f32 v132, v0
    s_waitcnt lgkmcnt(6)
    v_mfma_f32_32x32x16_bf16 v[64:79], a[4:7], v[112:115], v[64:79]
    ds_read_b64_tr_b16 a[24:25], v146 offset:20992
    ds_read_b64_tr_b16 a[26:27], v146 offset:23040
    v_exp_f32 v133, v1
    s_nop 0
    v_add_f32 v141, v132, v133
    v_mfma_f32_32x32x16_bf16 v[80:95], a[8:11], v[112:115], v[80:95]
    ds_read_b64_tr_b16 a[28:29], v146 offset:21248
    ds_read_b64_tr_b16 a[30:31], v146 offset:23296
    s_add_u32 s27, s43, s26
    s_and_b32 s27, s27, 0x3ffff
    s_add_u32 m0, s42, 0x0
    s_add_u32 s43, s43, 0x4000
    buffer_load_dwordx4 v147, s[8:11], s27 offen offset:0 nt lds
    s_waitcnt lgkmcnt(4)
    v_mfma_f32_32x32x16_bf16 v[96:111], a[12:15], v[112:115], v[96:111]
    ds_read_b128 a[0:3], v144 offset:49152
    v_cvt_pk_bf16_f32 v112, v132, v133
    v_exp_f32 v134, v2
    v_exp_f32 v135, v3
    v_add_f32 v141, v141, v134
    v_add_f32 v141, v141, v135
    v_cvt_pk_bf16_f32 v113, v134, v135
    v_mfma_f32_32x32x16_bf16 v[48:63], a[16:19], v[116:119], v[48:63]
    ds_read_b128 a[4:7], v145 offset:49152
    v_exp_f32 v132, v4
    v_exp_f32 v133, v5
    buffer_load_dwordx4 v149, s[8:11], s27 offen offset:1024 nt lds
    v_mfma_f32_32x32x16_bf16 v[64:79], a[20:23], v[116:119], v[64:79]
    ds_read_b128 a[8:11], v144 offset:49408
    v_add_f32 v141, v141, v132
    v_add_f32 v141, v141, v133
    v_cvt_pk_bf16_f32 v114, v132, v133
    s_waitcnt lgkmcnt(2)
    v_mfma_f32_32x32x16_bf16 v[80:95], a[24:27], v[116:119], v[80:95]
    ds_read_b128 a[12:15], v145 offset:49408
    v_exp_f32 v134, v6
    v_exp_f32 v135, v7
    v_add_f32 v141, v141, v134
    v_add_f32 v141, v141, v135
    v_cvt_pk_bf16_f32 v115, v134, v135
    buffer_load_dwordx4 v147, s[8:11], s27 offen offset:2048 nt lds
    buffer_load_dwordx4 v149, s[8:11], s27 offen offset:3072 nt lds
    v_mfma_f32_32x32x16_bf16 v[96:111], a[28:31], v[116:119], v[96:111]
    s_waitcnt vmcnt(12)
    s_barrier
    v_mfma_f32_32x32x16_bf16 v[16:31], a[0:3], v[156:159], v[32:47]
    ds_read_b128 a[16:19], v144 offset:49664
    ds_read_b128 a[20:23], v145 offset:49664
    v_exp_f32 v132, v8
    v_exp_f32 v133, v9
    s_waitcnt lgkmcnt(2)
    v_mfma_f32_32x32x16_bf16 v[16:31], a[4:7], v[160:163], v[16:31]
    ds_read_b128 a[24:27], v144 offset:49920
    v_add_f32 v141, v141, v132
    v_add_f32 v141, v141, v133
    v_cvt_pk_bf16_f32 v116, v132, v133
    v_mfma_f32_32x32x16_bf16 v[16:31], a[8:11], v[164:167], v[16:31]
    ds_read_b128 a[28:31], v145 offset:49920
    v_exp_f32 v134, v10
    v_exp_f32 v135, v11
    s_add_u32 s27, s41, s26
    s_and_b32 s27, s27, 0x3ffff
    s_cmp_lt_u32 s41, 0x40000
    s_cselect_b32 s27, s27, 0x100000
    s_add_u32 m0, s42, 0x18000
    s_add_u32 s41, s41, 0x4000
    buffer_load_dwordx4 v147, s[4:7], s27 offen offset:0 nt lds
    v_mfma_f32_32x32x16_bf16 v[16:31], a[12:15], v[168:171], v[16:31]
    v_add_f32 v141, v141, v134
    v_add_f32 v141, v141, v135
    v_cvt_pk_bf16_f32 v117, v134, v135
    s_waitcnt lgkmcnt(0)
    v_mfma_f32_32x32x16_bf16 v[16:31], a[16:19], v[172:175], v[16:31]
    ds_read_b64_tr_b16 a[0:1], v146 offset:32768
    ds_read_b64_tr_b16 a[2:3], v146 offset:34816
    v_exp_f32 v132, v12
    v_exp_f32 v133, v13
    v_mfma_f32_32x32x16_bf16 v[16:31], a[20:23], v[176:179], v[16:31]
    ds_read_b64_tr_b16 a[4:5], v146 offset:33024
    ds_read_b64_tr_b16 a[6:7], v146 offset:35072
    v_add_f32 v141, v141, v132
    v_add_f32 v141, v141, v133
    v_cvt_pk_bf16_f32 v118, v132, v133
    buffer_load_dwordx4 v148, s[4:7], s27 offen offset:1024 nt lds
    v_mfma_f32_32x32x16_bf16 v[16:31], a[24:27], v[180:183], v[16:31]
    ds_read_b64_tr_b16 a[8:9], v146 offset:33280
    ds_read_b64_tr_b16 a[10:11], v146 offset:35328
    v_exp_f32 v134, v14
    v_exp_f32 v135, v15
    buffer_load_dwordx4 v149, s[4:7], s27 offen offset:2048 nt lds
    v_mfma_f32_32x32x16_bf16 v[16:31], a[28:31], v[184:187], v[16:31]
    v_add_f32 v141, v141, v134
    v_add_f32 v141, v141, v135
    v_cvt_pk_bf16_f32 v119, v134, v135
    v_cmp_nge_f32 vcc, 0x44800000, v141
    ds_read_b64_tr_b16 a[12:13], v146 offset:33536
    ds_read_b64_tr_b16 a[14:15], v146 offset:35584
    buffer_load_dwordx4 v143, s[4:7], s27 offen offset:3072 nt lds
    s_cbranch_vccnz L_rc_13
L_rb_14:
    v_add_f32 v140, v140, v141
    ds_read_b64_tr_b16 a[16:17], v146 offset:36864
    ds_read_b64_tr_b16 a[18:19], v146 offset:38912
    s_waitcnt lgkmcnt(4)
    v_mfma_f32_32x32x16_bf16 v[48:63], a[0:3], v[112:115], v[48:63]
    ds_read_b64_tr_b16 a[20:21], v146 offset:37120
    ds_read_b64_tr_b16 a[22:23], v146 offset:39168
    v_exp_f32 v132, v16
    v_mfma_f32_32x32x16_bf16 v[64:79], a[4:7], v[112:115], v[64:79]
    ds_read_b64_tr_b16 a[24:25], v146 offset:37376
    ds_read_b64_tr_b16 a[26:27], v146 offset:39424
    v_exp_f32 v133, v17
    s_nop 0
    v_add_f32 v141, v132, v133
    v_mfma_f32_32x32x16_bf16 v[80:95], a[8:11], v[112:115], v[80:95]
    ds_read_b64_tr_b16 a[28:29], v146 offset:37632
    ds_read_b64_tr_b16 a[30:31], v146 offset:39680
    s_add_u32 s27, s43, s26
    s_and_b32 s27, s27, 0x3ffff
    s_add_u32 m0, s42, 0x4000
    s_add_u32 s43, s43, 0x4000
    buffer_load_dwordx4 v147, s[8:11], s27 offen offset:0 nt lds
    s_waitcnt lgkmcnt(4)
    v_mfma_f32_32x32x16_bf16 v[96:111], a[12:15], v[112:115], v[96:111]
    ds_read_b128 a[0:3], v144 offset:0
    v_cvt_pk_bf16_f32 v112, v132, v133
    v_exp_f32 v134, v18
    v_exp_f32 v135, v19
    v_add_f32 v141, v141, v134
    v_add_f32 v141, v141, v135
    v_cvt_pk_bf16_f32 v113, v134, v135
    v_mfma_f32_32x32x16_bf16 v[48:63], a[16:19], v[116:119], v[48:63]
    ds_read_b128 a[4:7], v145 offset:0
    v_exp_f32 v132, v20
    v_exp_f32 v133, v21
    buffer_load_dwordx4 v149, s[8:11], s27 offen offset:1024 nt lds
    v_mfma_f32_32x32x16_bf16 v[64:79], a[20:23], v[116:119], v[64:79]
    ds_read_b128 a[8:11], v144 offset:256
    v_add_f32 v141, v141, v132
    v_add_f32 v141, v141, v133
    v_cvt_pk_bf16_f32 v114, v132, v133
    s_waitcnt lgkmcnt(2)
    v_mfma_f32_32x32x16_bf16 v[80:95], a[24:27], v[116:119], v[80:95]
    ds_read_b128 a[12:15], v145 offset:256
    v_exp_f32 v134, v22
    v_exp_f32 v135, v23
    v_add_f32 v141, v141, v134
    v_add_f32 v141, v141, v135
    v_cvt_pk_bf16_f32 v115, v134, v135
    buffer_load_dwordx4 v147, s[8:11], s27 offen offset:2048 nt lds
    buffer_load_dwordx4 v149, s[8:11], s27 offen offset:3072 nt lds
    v_mfma_f32_32x32x16_bf16 v[96:111], a[28:31], v[116:119], v[96:111]
    s_waitcnt vmcnt(12)
    s_barrier
    v_mfma_f32_32x32x16_bf16 v[0:15], a[0:3], v[156:159], v[32:47]
    ds_read_b128 a[16:19], v144 offset:512
    ds_read_b128 a[20:23], v145 offset:512
    v_exp_f32 v132, v24
    v_exp_f32 v133, v25
    s_waitcnt lgkmcnt(2)
    v_mfma_f32_32x32x16_bf16 v[0:15], a[4:7], v[160:163], v[0:15]
    ds_read_b128 a[24:27], v144 offset:768
    v_add_f32 v141, v141, v132
    v_add_f32 v141, v141, v133
    v_cvt_pk_bf16_f32 v116, v132, v133
    v_mfma_f32_32x32x16_bf16 v[0:15], a[8:11], v[164:167], v[0:15]
    ds_read_b128 a[28:31], v145 offset:768
    v_exp_f32 v134, v26
    v_exp_f32 v135, v27
    s_add_u32 s27, s41, s26
    s_and_b32 s27, s27, 0x3ffff
    s_cmp_lt_u32 s41, 0x40000
    s_cselect_b32 s27, s27, 0x100000
    s_add_u32 m0, s42, 0x1c000
    s_add_u32 s41, s41, 0x4000
    buffer_load_dwordx4 v147, s[4:7], s27 offen offset:0 nt lds
    v_mfma_f32_32x32x16_bf16 v[0:15], a[12:15], v[168:171], v[0:15]
    v_add_f32 v141, v141, v134
    v_add_f32 v141, v141, v135
    v_cvt_pk_bf16_f32 v117, v134, v135
    s_waitcnt lgkmcnt(0)
    v_mfma_f32_32x32x16_bf16 v[0:15], a[16:19], v[172:175], v[0:15]
    ds_read_b64_tr_b16 a[0:1], v146 offset:49152
    ds_read_b64_tr_b16 a[2:3], v146 offset:51200
    v_exp_f32 v132, v28
    v_exp_f32 v133, v29
    v_mfma_f32_32x32x16_bf16 v[0:15], a[20:23], v[176:179], v[0:15]
    ds_read_b64_tr_b16 a[4:5], v146 offset:49408
    ds_read_b64_tr_b16 a[6:7], v146 offset:51456
    v_add_f32 v141, v141, v132
    v_add_f32 v141, v141, v133
    v_cvt_pk_bf16_f32 v118, v132, v133
    buffer_load_dwordx4 v148, s[4:7], s27 offen offset:1024 nt lds
    v_mfma_f32_32x32x16_bf16 v[0:15], a[24:27], v[180:183], v[0:15]
    ds_read_b64_tr_b16 a[8:9], v146 offset:49664
    ds_read_b64_tr_b16 a[10:11], v146 offset:51712
    v_exp_f32 v134, v30
    v_exp_f32 v135, v31
    buffer_load_dwordx4 v149, s[4:7], s27 offen offset:2048 nt lds
    v_mfma_f32_32x32x16_bf16 v[0:15], a[28:31], v[184:187], v[0:15]
    v_add_f32 v141, v141, v134
    v_add_f32 v141, v141, v135
    v_cvt_pk_bf16_f32 v119, v134, v135
    v_cmp_nge_f32 vcc, 0x44800000, v141
    ds_read_b64_tr_b16 a[12:13], v146 offset:49920
    ds_read_b64_tr_b16 a[14:15], v146 offset:51968
    buffer_load_dwordx4 v143, s[4:7], s27 offen offset:3072 nt lds
    s_cbranch_vccnz L_rc_15
L_rb_16:
    v_add_f32 v140, v140, v141
    ds_read_b64_tr_b16 a[16:17], v146 offset:53248
    ds_read_b64_tr_b16 a[18:19], v146 offset:55296
    s_waitcnt lgkmcnt(4)
    v_mfma_f32_32x32x16_bf16 v[48:63], a[0:3], v[112:115], v[48:63]
    ds_read_b64_tr_b16 a[20:21], v146 offset:53504
    ds_read_b64_tr_b16 a[22:23], v146 offset:55552
    v_exp_f32 v132, v0
    v_mfma_f32_32x32x16_bf16 v[64:79], a[4:7], v[112:115], v[64:79]
    ds_read_b64_tr_b16 a[24:25], v146 offset:53760
    ds_read_b64_tr_b16 a[26:27], v146 offset:55808
    v_exp_f32 v133, v1
    s_nop 0
    v_add_f32 v141, v132, v133
    v_mfma_f32_32x32x16_bf16 v[80:95], a[8:11], v[112:115], v[80:95]
    ds_read_b64_tr_b16 a[28:29], v146 offset:54016
    ds_read_b64_tr_b16 a[30:31], v146 offset:56064
    s_add_u32 s27, s43, s26
    s_and_b32 s27, s27, 0x3ffff
    s_add_u32 m0, s42, 0x8000
    s_add_u32 s43, s43, 0x4000
    buffer_load_dwordx4 v147, s[8:11], s27 offen offset:0 nt lds
    s_waitcnt lgkmcnt(4)
    v_mfma_f32_32x32x16_bf16 v[96:111], a[12:15], v[112:115], v[96:111]
    ds_read_b128 a[0:3], v144 offset:16384
    v_cvt_pk_bf16_f32 v112, v132, v133
    v_exp_f32 v134, v2
    v_exp_f32 v135, v3
    v_add_f32 v141, v141, v134
    v_add_f32 v141, v141, v135
    v_cvt_pk_bf16_f32 v113, v134, v135
    v_mfma_f32_32x32x16_bf16 v[48:63], a[16:19], v[116:119], v[48:63]
    ds_read_b128 a[4:7], v145 offset:16384
    v_exp_f32 v132, v4
    v_exp_f32 v133, v5
    buffer_load_dwordx4 v149, s[8:11], s27 offen offset:1024 nt lds
    v_mfma_f32_32x32x16_bf16 v[64:79], a[20:23], v[116:119], v[64:79]
    ds_read_b128 a[8:11], v144 offset:16640
    v_add_f32 v141, v141, v132
    v_add_f32 v141, v141, v133
    v_cvt_pk_bf16_f32 v114, v132, v133
    s_waitcnt lgkmcnt(2)
    v_mfma_f32_32x32x16_bf16 v[80:95], a[24:27], v[116:119], v[80:95]
    ds_read_b128 a[12:15], v145 offset:16640
    v_exp_f32 v134, v6
    v_exp_f32 v135, v7
    v_add_f32 v141, v141, v134
    v_add_f32 v141, v141, v135
    v_cvt_pk_bf16_f32 v115, v134, v135
    buffer_load_dwordx4 v147, s[8:11], s27 offen offset:2048 nt lds
    buffer_load_dwordx4 v149, s[8:11], s27 offen offset:3072 nt lds
    v_mfma_f32_32x32x16_bf16 v[96:111], a[28:31], v[116:119], v[96:111]
    s_waitcnt vmcnt(12)
    s_barrier
    v_mfma_f32_32x32x16_bf16 v[16:31], a[0:3], v[156:159], v[32:47]
    ds_read_b128 a[16:19], v144 offset:16896
    ds_read_b128 a[20:23], v145 offset:16896
    v_exp_f32 v132, v8
    v_exp_f32 v133, v9
    s_waitcnt lgkmcnt(2)
    v_mfma_f32_32x32x16_bf16 v[16:31], a[4:7], v[160:163], v[16:31]
    ds_read_b128 a[24:27], v144 offset:17152
    v_add_f32 v141, v141, v132
    v_add_f32 v141, v141, v133
    v_cvt_pk_bf16_f32 v116, v132, v133
    v_mfma_f32_32x32x16_bf16 v[16:31], a[8:11], v[164:167], v[16:31]
    ds_read_b128 a[28:31], v145 offset:17152
    v_exp_f32 v134, v10
    v_exp_f32 v135, v11
    s_add_u32 s27, s41, s26
    s_and_b32 s27, s27, 0x3ffff
    s_cmp_lt_u32 s41, 0x40000
    s_cselect_b32 s27, s27, 0x100000
    s_add_u32 m0, s42, 0x10000
    s_add_u32 s41, s41, 0x4000
    buffer_load_dwordx4 v147, s[4:7], s27 offen offset:0 nt lds
    v_mfma_f32_32x32x16_bf16 v[16:31], a[12:15], v[168:171], v[16:31]
    v_add_f32 v141, v141, v134
    v_add_f32 v141, v141, v135
    v_cvt_pk_bf16_f32 v117, v134, v135
    s_waitcnt lgkmcnt(0)
    v_mfma_f32_32x32x16_bf16 v[16:31], a[16:19], v[172:175], v[16:31]
    ds_read_b64_tr_b16 a[0:1], v146 offset:0
    ds_read_b64_tr_b16 a[2:3], v146 offset:2048
    v_exp_f32 v132, v12
    v_exp_f32 v133, v13
    v_mfma_f32_32x32x16_bf16 v[16:31], a[20:23], v[176:179], v[16:31]
    ds_read_b64_tr_b16 a[4:5], v146 offset:256
    ds_read_b64_tr_b16 a[6:7], v146 offset:2304
    v_add_f32 v141, v141, v132
    v_add_f32 v141, v141, v133
    v_cvt_pk_bf16_f32 v118, v132, v133
    buffer_load_dwordx4 v148, s[4:7], s27 offen offset:1024 nt lds
    v_mfma_f32_32x32x16_bf16 v[16:31], a[24:27], v[180:183], v[16:31]
    ds_read_b64_tr_b16 a[8:9], v146 offset:512
    ds_read_b64_tr_b16 a[10:11], v146 offset:2560
    v_exp_f32 v134, v14
    v_exp_f32 v135, v15
    buffer_load_dwordx4 v149, s[4:7], s27 offen offset:2048 nt lds
    v_mfma_f32_32x32x16_bf16 v[16:31], a[28:31], v[184:187], v[16:31]
    v_add_f32 v141, v141, v134
    v_add_f32 v141, v141, v135
    v_cvt_pk_bf16_f32 v119, v134, v135
    v_cmp_nge_f32 vcc, 0x44800000, v141
    ds_read_b64_tr_b16 a[12:13], v146 offset:768
    ds_read_b64_tr_b16 a[14:15], v146 offset:2816
    buffer_load_dwordx4 v143, s[4:7], s27 offen offset:3072 nt lds
    s_cbranch_vccnz L_rc_17
L_rb_18:
    v_add_f32 v140, v140, v141
    ds_read_b64_tr_b16 a[16:17], v146 offset:4096
    ds_read_b64_tr_b16 a[18:19], v146 offset:6144
    s_waitcnt lgkmcnt(4)
    v_mfma_f32_32x32x16_bf16 v[48:63], a[0:3], v[112:115], v[48:63]
    ds_read_b64_tr_b16 a[20:21], v146 offset:4352
    ds_read_b64_tr_b16 a[22:23], v146 offset:6400
    v_exp_f32 v132, v16
    v_mfma_f32_32x32x16_bf16 v[64:79], a[4:7], v[112:115], v[64:79]
    ds_read_b64_tr_b16 a[24:25], v146 offset:4608
    ds_read_b64_tr_b16 a[26:27], v146 offset:6656
    v_exp_f32 v133, v17
    s_nop 0
    v_add_f32 v141, v132, v133
    v_mfma_f32_32x32x16_bf16 v[80:95], a[8:11], v[112:115], v[80:95]
    ds_read_b64_tr_b16 a[28:29], v146 offset:4864
    ds_read_b64_tr_b16 a[30:31], v146 offset:6912
    s_add_u32 s27, s43, s26
    s_and_b32 s27, s27, 0x3ffff
    s_add_u32 m0, s42, 0xc000
    s_add_u32 s43, s43, 0x4000
    buffer_load_dwordx4 v147, s[8:11], s27 offen offset:0 nt lds
    s_waitcnt lgkmcnt(4)
    v_mfma_f32_32x32x16_bf16 v[96:111], a[12:15], v[112:115], v[96:111]
    ds_read_b128 a[0:3], v144 offset:32768
    v_cvt_pk_bf16_f32 v112, v132, v133
    v_exp_f32 v134, v18
    v_exp_f32 v135, v19
    v_add_f32 v141, v141, v134
    v_add_f32 v141, v141, v135
    v_cvt_pk_bf16_f32 v113, v134, v135
    v_mfma_f32_32x32x16_bf16 v[48:63], a[16:19], v[116:119], v[48:63]
    ds_read_b128 a[4:7], v145 offset:32768
    v_exp_f32 v132, v20
    v_exp_f32 v133, v21
    buffer_load_dwordx4 v149, s[8:11], s27 offen offset:1024 nt lds
    v_mfma_f32_32x32x16_bf16 v[64:79], a[20:23], v[116:119], v[64:79]
    ds_read_b128 a[8:11], v144 offset:33024
    v_add_f32 v141, v141, v132
    v_add_f32 v141, v141, v133
    v_cvt_pk_bf16_f32 v114, v132, v133
    s_waitcnt lgkmcnt(2)
    v_mfma_f32_32x32x16_bf16 v[80:95], a[24:27], v[116:119], v[80:95]
    ds_read_b128 a[12:15], v145 offset:33024
    v_exp_f32 v134, v22
    v_exp_f32 v135, v23
    v_add_f32 v141, v141, v134
    v_add_f32 v141, v141, v135
    v_cvt_pk_bf16_f32 v115, v134, v135
    buffer_load_dwordx4 v147, s[8:11], s27 offen offset:2048 nt lds
    buffer_load_dwordx4 v149, s[8:11], s27 offen offset:3072 nt lds
    v_mfma_f32_32x32x16_bf16 v[96:111], a[28:31], v[116:119], v[96:111]
    s_waitcnt vmcnt(12)
    s_barrier
    s_sub_u32 s21, s21, 1
    s_cmp_lg_u32 s21, 0
    s_cbranch_scc1 L_loop0
    v_mfma_f32_32x32x16_bf16 v[0:15], a[0:3], v[156:159], v[32:47]
    ds_read_b128 a[16:19], v144 offset:33280
    ds_read_b128 a[20:23], v145 offset:33280
    v_exp_f32 v132, v24
    v_exp_f32 v133, v25
    s_waitcnt lgkmcnt(2)
    v_mfma_f32_32x32x16_bf16 v[0:15], a[4:7], v[160:163], v[0:15]
    ds_read_b128 a[24:27], v144 offset:33536
    v_add_f32 v141, v141, v132
    v_add_f32 v141, v141, v133
    v_cvt_pk_bf16_f32 v116, v132, v133
    v_mfma_f32_32x32x16_bf16 v[0:15], a[8:11], v[164:167], v[0:15]
    ds_read_b128 a[28:31], v145 offset:33536
    v_exp_f32 v134, v26
    v_exp_f32 v135, v27
    v_mfma_f32_32x32x16_bf16 v[0:15], a[12:15], v[168:171], v[0:15]
    v_add_f32 v141, v141, v134
    v_add_f32 v141, v141, v135
    v_cvt_pk_bf16_f32 v117, v134, v135
    s_waitcnt lgkmcnt(2)
    v_mfma_f32_32x32x16_bf16 v[0:15], a[16:19], v[172:175], v[0:15]
    ds_read_b64_tr_b16 a[0:1], v146 offset:16384
    ds_read_b64_tr_b16 a[2:3], v146 offset:18432
    v_exp_f32 v132, v28
    v_exp_f32 v133, v29
    v_mfma_f32_32x32x16_bf16 v[0:15], a[20:23], v[176:179], v[0:15]
    ds_read_b64_tr_b16 a[4:5], v146 offset:16640
    ds_read_b64_tr_b16 a[6:7], v146 offset:18688
    v_add_f32 v141, v141, v132
    v_add_f32 v141, v141, v133
    v_cvt_pk_bf16_f32 v118, v132, v133
    s_waitcnt lgkmcnt(4)
    v_mfma_f32_32x32x16_bf16 v[0:15], a[24:27], v[180:183], v[0:15]
    ds_read_b64_tr_b16 a[8:9], v146 offset:16896
    ds_read_b64_tr_b16 a[10:11], v146 offset:18944
    v_exp_f32 v134, v30
    v_exp_f32 v135, v31
    v_mfma_f32_32x32x16_bf16 v[0:15], a[28:31], v[184:187], v[0:15]
    v_add_f32 v141, v141, v134
    v_add_f32 v141, v141, v135
    v_cvt_pk_bf16_f32 v119, v134, v135
    v_cmp_nge_f32 vcc, 0x44800000, v141
    ds_read_b64_tr_b16 a[12:13], v146 offset:17152
    ds_read_b64_tr_b16 a[14:15], v146 offset:19200
    s_cbranch_vccnz L_rc_19
L_rb_20:
    v_add_f32 v140, v140, v141
    ds_read_b64_tr_b16 a[16:17], v146 offset:20480
    ds_read_b64_tr_b16 a[18:19], v146 offset:22528
    s_waitcnt lgkmcnt(4)
    v_mfma_f32_32x32x16_bf16 v[48:63], a[0:3], v[112:115], v[48:63]
    ds_read_b64_tr_b16 a[20:21], v146 offset:20736
    ds_read_b64_tr_b16 a[22:23], v146 offset:22784
    v_exp_f32 v132, v0
    v_mfma_f32_32x32x16_bf16 v[64:79], a[4:7], v[112:115], v[64:79]
    ds_read_b64_tr_b16 a[24:25], v146 offset:20992
    ds_read_b64_tr_b16 a[26:27], v146 offset:23040
    v_exp_f32 v133, v1
    s_nop 0
    v_add_f32 v141, v132, v133
    v_mfma_f32_32x32x16_bf16 v[80:95], a[8:11], v[112:115], v[80:95]
    ds_read_b64_tr_b16 a[28:29], v146 offset:21248
    ds_read_b64_tr_b16 a[30:31], v146 offset:23296
    s_waitcnt lgkmcnt(6)
    v_mfma_f32_32x32x16_bf16 v[96:111], a[12:15], v[112:115], v[96:111]
    ds_read_b128 a[0:3], v144 offset:49152
    v_cvt_pk_bf16_f32 v112, v132, v133
    v_exp_f32 v134, v2
    v_exp_f32 v135, v3
    v_add_f32 v141, v141, v134
    v_add_f32 v141, v141, v135
    v_cvt_pk_bf16_f32 v113, v134, v135
    v_mfma_f32_32x32x16_bf16 v[48:63], a[16:19], v[116:119], v[48:63]
    ds_read_b128 a[4:7], v145 offset:49152
    v_exp_f32 v132, v4
    v_exp_f32 v133, v5
    s_waitcnt lgkmcnt(2)
    v_mfma_f32_32x32x16_bf16 v[64:79], a[20:23], v[116:119], v[64:79]
    ds_read_b128 a[8:11], v144 offset:49408
    v_add_f32 v141, v141, v132
    v_add_f32 v141, v141, v133
    v_cvt_pk_bf16_f32 v114, v132, v133
    v_mfma_f32_32x32x16_bf16 v[80:95], a[24:27], v[116:119], v[80:95]
    ds_read_b128 a[12:15], v145 offset:49408
    v_exp_f32 v134, v6
    v_exp_f32 v135, v7
    v_add_f32 v141, v141, v134
    v_add_f32 v141, v141, v135
    v_cvt_pk_bf16_f32 v115, v134, v135
    v_mfma_f32_32x32x16_bf16 v[96:111], a[28:31], v[116:119], v[96:111]
    s_waitcnt vmcnt(8)
    s_barrier
    s_waitcnt lgkmcnt(1)
    v_mfma_f32_32x32x16_bf16 v[16:31], a[0:3], v[156:159], v[32:47]
    ds_read_b128 a[16:19], v144 offset:49664
    ds_read_b128 a[20:23], v145 offset:49664
    v_exp_f32 v132, v8
    v_exp_f32 v133, v9
    v_mfma_f32_32x32x16_bf16 v[16:31], a[4:7], v[160:163], v[16:31]
    ds_read_b128 a[24:27], v144 offset:49920
    v_add_f32 v141, v141, v132
    v_add_f32 v141, v141, v133
    v_cvt_pk_bf16_f32 v116, v132, v133
    v_mfma_f32_32x32x16_bf16 v[16:31], a[8:11], v[164:167], v[16:31]
    ds_read_b128 a[28:31], v145 offset:49920
    v_exp_f32 v134, v10
    v_exp_f32 v135, v11
    s_waitcnt lgkmcnt(4)
    v_mfma_f32_32x32x16_bf16 v[16:31], a[12:15], v[168:171], v[16:31]
    v_add_f32 v141, v141, v134
    v_add_f32 v141, v141, v135
    v_cvt_pk_bf16_f32 v117, v134, v135
    s_waitcnt lgkmcnt(2)
    v_mfma_f32_32x32x16_bf16 v[16:31], a[16:19], v[172:175], v[16:31]
    ds_read_b64_tr_b16 a[0:1], v146 offset:32768
    ds_read_b64_tr_b16 a[2:3], v146 offset:34816
    v_exp_f32 v132, v12
    v_exp_f32 v133, v13
    v_mfma_f32_32x32x16_bf16 v[16:31], a[20:23], v[176:179], v[16:31]
    ds_read_b64_tr_b16 a[4:5], v146 offset:33024
    ds_read_b64_tr_b16 a[6:7], v146 offset:35072
    v_add_f32 v141, v141, v132
    v_add_f32 v141, v141, v133
    v_cvt_pk_bf16_f32 v118, v132, v133
    s_waitcnt lgkmcnt(4)
    v_mfma_f32_32x32x16_bf16 v[16:31], a[24:27], v[180:183], v[16:31]
    ds_read_b64_tr_b16 a[8:9], v146 offset:33280
    ds_read_b64_tr_b16 a[10:11], v146 offset:35328
    v_exp_f32 v134, v14
    v_exp_f32 v135, v15
    v_mfma_f32_32x32x16_bf16 v[16:31], a[28:31], v[184:187], v[16:31]
    v_add_f32 v141, v141, v134
    v_add_f32 v141, v141, v135
    v_cvt_pk_bf16_f32 v119, v134, v135
    v_cmp_nge_f32 vcc, 0x44800000, v141
    ds_read_b64_tr_b16 a[12:13], v146 offset:33536
    ds_read_b64_tr_b16 a[14:15], v146 offset:35584
    s_cbranch_vccnz L_rc_21
L_rb_22:
    v_add_f32 v140, v140, v141
    ds_read_b64_tr_b16 a[16:17], v146 offset:36864
    ds_read_b64_tr_b16 a[18:19], v146 offset:38912
    s_waitcnt lgkmcnt(4)
    v_mfma_f32_32x32x16_bf16 v[48:63], a[0:3], v[112:115], v[48:63]
    ds_read_b64_tr_b16 a[20:21], v146 offset:37120
    ds_read_b64_tr_b16 a[22:23], v146 offset:39168
    v_exp_f32 v132, v16
    v_mfma_f32_32x32x16_bf16 v[64:79], a[4:7], v[112:115], v[64:79]
    ds_read_b64_tr_b16 a[24:25], v146 offset:37376
    ds_read_b64_tr_b16 a[26:27], v146 offset:39424
    v_exp_f32 v133, v17
    s_nop 0
    v_add_f32 v141, v132, v133
    v_mfma_f32_32x32x16_bf16 v[80:95], a[8:11], v[112:115], v[80:95]
    ds_read_b64_tr_b16 a[28:29], v146 offset:37632
    ds_read_b64_tr_b16 a[30:31], v146 offset:39680
    s_waitcnt lgkmcnt(6)
    v_mfma_f32_32x32x16_bf16 v[96:111], a[12:15], v[112:115], v[96:111]
    v_cvt_pk_bf16_f32 v112, v132, v133
    v_exp_f32 v134, v18
    v_exp_f32 v135, v19
    v_add_f32 v141, v141, v134
    v_add_f32 v141, v141, v135
    v_cvt_pk_bf16_f32 v113, v134, v135
    v_mfma_f32_32x32x16_bf16 v[48:63], a[16:19], v[116:119], v[48:63]
    v_exp_f32 v132, v20
    v_exp_f32 v133, v21
    s_waitcnt lgkmcnt(2)
    v_mfma_f32_32x32x16_bf16 v[64:79], a[20:23], v[116:119], v[64:79]
    v_add_f32 v141, v141, v132
    v_add_f32 v141, v141, v133
    v_cvt_pk_bf16_f32 v114, v132, v133
    v_mfma_f32_32x32x16_bf16 v[80:95], a[24:27], v[116:119], v[80:95]
    v_exp_f32 v134, v22
    v_exp_f32 v135, v23
    v_add_f32 v141, v141, v134
    v_add_f32 v141, v141, v135
    v_cvt_pk_bf16_f32 v115, v134, v135
    s_waitcnt lgkmcnt(0)
    v_mfma_f32_32x32x16_bf16 v[96:111], a[28:31], v[116:119], v[96:111]
    s_waitcnt vmcnt(0)
    s_barrier
    s_lshl_b32 s46, s58, 14
    s_add_u32 s46, s46, 0x10000
    v_add_u32 v144, s46, v150
    v_lshrrev_b32 v187, 1, v150
    s_lshl_b32 s46, s58, 9
    s_add_u32 s46, s46, 0x21000
    v_add_u32 v145, s46, v187
    s_lshl_b32 s46, s58, 13
    s_add_u32 s46, s46, 0x0
    v_add_u32 v147, s46, v150
    ds_read_b64_tr_b16 a[0:1], v146 offset:49664
    ds_read_b64_tr_b16 a[2:3], v146 offset:51712
    ds_read_b64_tr_b16 a[4:5], v146 offset:53760
    ds_read_b64_tr_b16 a[6:7], v146 offset:55808
    ds_read_b64_tr_b16 a[8:9], v146 offset:49920
    ds_read_b64_tr_b16 a[10:11], v146 offset:51968
    ds_read_b64_tr_b16 a[12:13], v146 offset:54016
    ds_read_b64_tr_b16 a[14:15], v146 offset:56064
    ds_read_b64_tr_b16 a[16:17], v146 offset:49152
    ds_read_b64_tr_b16 a[18:19], v146 offset:51200
    ds_read_b64_tr_b16 a[20:21], v146 offset:53248
    ds_read_b64_tr_b16 a[22:23], v146 offset:55296
    ds_read_b64_tr_b16 a[24:25], v146 offset:49408
    ds_read_b64_tr_b16 a[26:27], v146 offset:51456
    v_exp_f32 v132, v24
    v_exp_f32 v133, v25
    v_add_f32 v141, v141, v132
    v_add_f32 v141, v141, v133
    v_cvt_pk_bf16_f32 v116, v132, v133
    v_exp_f32 v134, v26
    v_exp_f32 v135, v27
    v_add_f32 v141, v141, v134
    v_add_f32 v141, v141, v135
    v_cvt_pk_bf16_f32 v117, v134, v135
    v_exp_f32 v132, v28
    v_exp_f32 v133, v29
    v_add_f32 v141, v141, v132
    v_add_f32 v141, v141, v133
    v_cvt_pk_bf16_f32 v118, v132, v133
    v_exp_f32 v134, v30
    v_exp_f32 v135, v31
    v_add_f32 v141, v141, v134
    v_add_f32 v141, v141, v135
    v_cvt_pk_bf16_f32 v119, v134, v135
    v_cmp_nge_f32 vcc, 0x44800000, v141
    s_cbranch_vccnz L_rc_23
L_rb_24:
    v_add_f32 v140, v140, v141
    s_waitcnt lgkmcnt(0)
    v_mfma_f32_32x32x16_bf16 v[80:95], a[0:3], v[112:115], v[80:95]
    ds_read_b64_tr_b16 a[28:29], v146 offset:53504
    ds_read_b64_tr_b16 a[30:31], v146 offset:55552
    v_mov_b32 v154, v32
    v_mov_b32 v155, v140
    ds_write_b64 v145, v[154:155] offset:0
    v_mfma_f32_32x32x16_bf16 v[80:95], a[4:7], v[116:119], v[80:95]
    v_mfma_f32_32x32x16_bf16 v[96:111], a[8:11], v[112:115], v[96:111]
    s_nop 10
    ds_write_b128 v144, v[80:83] offset:8192
    ds_write_b128 v144, v[84:87] offset:9216
    ds_write_b128 v144, v[88:91] offset:10240
    ds_write_b128 v144, v[92:95] offset:11264
    v_mfma_f32_32x32x16_bf16 v[96:111], a[12:15], v[116:119], v[96:111]
    v_mfma_f32_32x32x16_bf16 v[48:63], a[16:19], v[112:115], v[48:63]
    s_nop 10
    ds_write_b128 v144, v[96:99] offset:12288
    ds_write_b128 v144, v[100:103] offset:13312
    ds_write_b128 v144, v[104:107] offset:14336
    ds_write_b128 v144, v[108:111] offset:15360
    v_mfma_f32_32x32x16_bf16 v[48:63], a[20:23], v[116:119], v[48:63]
    v_mfma_f32_32x32x16_bf16 v[64:79], a[24:27], v[112:115], v[64:79]
    s_waitcnt lgkmcnt(8)
    v_mfma_f32_32x32x16_bf16 v[64:79], a[28:31], v[116:119], v[64:79]
    s_waitcnt lgkmcnt(0)
    s_barrier
    ds_read_b64 v[132:133], v145 offset:2048
    ds_read_b128 v[0:3], v144 offset:0
    ds_read_b128 v[4:7], v144 offset:1024
    ds_read_b128 v[8:11], v144 offset:2048
    ds_read_b128 v[12:15], v144 offset:3072
    ds_read_b128 v[16:19], v144 offset:4096
    ds_read_b128 v[20:23], v144 offset:5120
    ds_read_b128 v[24:27], v144 offset:6144
    ds_read_b128 v[28:31], v144 offset:7168
    v_add_u32 v155, 0x22000, v187
    s_lshl_b32 s46, s58, 11
    s_add_u32 s46, s46, 0x0
    v_add_u32 v154, s46, v150
    s_lshl_b32 s46, s20, 12
    s_add_u32 s46, s46, 0x8000
    v_lshrrev_b32 v149, 4, v150
    v_and_b32 v152, 31, v149
    v_and_b32 v148, 7, v149
    v_lshlrev_b32 v152, 7, v152
    v_lshl_or_b32 v152, v148, 4, v152
    v_lshrrev_b32 v153, 5, v149
    v_lshl_or_b32 v152, v153, 3, v152
    v_add_u32 v152, s46, v152
    v_lshrrev_b32 v149, 3, v149
    v_xor_b32 v153, v149, v148
    v_and_b32 v153, 7, v153
    v_lshlrev_b32 v153, 4, v153
    v_lshl_or_b32 v153, v149, 7, v153
    v_add_u32 v153, s46, v153
    s_lshl_b32 s46, s58, 5
    v_add_u32 v149, s46, v149
    v_lshlrev_b32 v149, 8, v149
    v_lshl_or_b32 v148, v148, 4, v149
    v_lshrrev_b32 v149, 4, v150
    v_and_b32 v146, 15, v149
    v_lshrrev_b32 v149, 4, v149
    v_add_u32 v146, 128, v146
    v_lshlrev_b32 v146, 8, v146
    v_lshl_or_b32 v146, v149, 3, v146
    s_lshl_b32 s46, s58, 6
    v_add_u32 v146, s46, v146
    ds_read_b64 v[156:157], v155 offset:0
    ds_read_b64 v[158:159], v155 offset:512
    ds_read_b64 v[160:161], v155 offset:1024
    ds_read_b64 v[162:163], v155 offset:1536
    s_waitcnt lgkmcnt(4)
    v_min_f32 v120, v32, v132
    v_sub_f32 v122, v120, v32
    v_sub_f32 v124, v120, v132
    v_exp_f32 v122, v122
    v_exp_f32 v124, v124
    v_mul_f32 v121, v122, v140
    v_fmac_f32 v121, v124, v133
    v_mov_b32 v123, v121
    s_nop 1
    v_permlane32_swap_b32 v121, v123
    v_add_f32 v121, v121, v123
    v_rcp_f32 v121, v121
    s_nop 0
    v_mul_f32 v122, v122, v121
    v_mul_f32 v124, v124, v121
    v_pk_mul_f32 v[48:49], v[48:49], v[122:123] op_sel_hi:[1,0]
    v_pk_mul_f32 v[50:51], v[50:51], v[122:123] op_sel_hi:[1,0]
    v_pk_mul_f32 v[52:53], v[52:53], v[122:123] op_sel_hi:[1,0]
    v_pk_mul_f32 v[54:55], v[54:55], v[122:123] op_sel_hi:[1,0]
    v_pk_mul_f32 v[56:57], v[56:57], v[122:123] op_sel_hi:[1,0]
    v_pk_mul_f32 v[58:59], v[58:59], v[122:123] op_sel_hi:[1,0]
    v_pk_mul_f32 v[60:61], v[60:61], v[122:123] op_sel_hi:[1,0]
    v_pk_mul_f32 v[62:63], v[62:63], v[122:123] op_sel_hi:[1,0]
    v_pk_fma_f32 v[48:49], v[0:1], v[124:125], v[48:49] op_sel_hi:[1,0,1]
    v_pk_fma_f32 v[50:51], v[2:3], v[124:125], v[50:51] op_sel_hi:[1,0,1]
    v_pk_fma_f32 v[52:53], v[4:5], v[124:125], v[52:53] op_sel_hi:[1,0,1]
    v_pk_fma_f32 v[54:55], v[6:7], v[124:125], v[54:55] op_sel_hi:[1,0,1]
    v_pk_fma_f32 v[56:57], v[8:9], v[124:125], v[56:57] op_sel_hi:[1,0,1]
    v_pk_fma_f32 v[58:59], v[10:11], v[124:125], v[58:59] op_sel_hi:[1,0,1]
    v_pk_fma_f32 v[60:61], v[12:13], v[124:125], v[60:61] op_sel_hi:[1,0,1]
    v_pk_fma_f32 v[62:63], v[14:15], v[124:125], v[62:63] op_sel_hi:[1,0,1]
    ds_read_b128 v[164:167], v154 offset:0
    ds_read_b128 v[168:171], v154 offset:8192
    ds_read_b128 v[172:175], v154 offset:16384
    ds_read_b128 v[176:179], v154 offset:24576
    v_cvt_pk_bf16_f32 v32, v48, v49
    v_cvt_pk_bf16_f32 v33, v50, v51
    v_cvt_pk_bf16_f32 v34, v52, v53
    v_cvt_pk_bf16_f32 v35, v54, v55
    v_cvt_pk_bf16_f32 v36, v56, v57
    v_cvt_pk_bf16_f32 v37, v58, v59
    v_cvt_pk_bf16_f32 v38, v60, v61
    v_cvt_pk_bf16_f32 v39, v62, v63
    v_xor_b32 v125, 0, v152
    ds_write_b64 v125, v[32:33]
    v_xor_b32 v126, 16, v152
    ds_write_b64 v126, v[34:35]
    v_xor_b32 v125, 32, v152
    ds_write_b64 v125, v[36:37]
    v_xor_b32 v126, 48, v152
    ds_write_b64 v126, v[38:39]
    v_pk_mul_f32 v[64:65], v[64:65], v[122:123] op_sel_hi:[1,0]
    v_pk_mul_f32 v[66:67], v[66:67], v[122:123] op_sel_hi:[1,0]
    v_pk_mul_f32 v[68:69], v[68:69], v[122:123] op_sel_hi:[1,0]
    v_pk_mul_f32 v[70:71], v[70:71], v[122:123] op_sel_hi:[1,0]
    v_pk_mul_f32 v[72:73], v[72:73], v[122:123] op_sel_hi:[1,0]
    v_pk_mul_f32 v[74:75], v[74:75], v[122:123] op_sel_hi:[1,0]
    v_pk_mul_f32 v[76:77], v[76:77], v[122:123] op_sel_hi:[1,0]
    v_pk_mul_f32 v[78:79], v[78:79], v[122:123] op_sel_hi:[1,0]
    v_pk_fma_f32 v[64:65], v[16:17], v[124:125], v[64:65] op_sel_hi:[1,0,1]
    v_pk_fma_f32 v[66:67], v[18:19], v[124:125], v[66:67] op_sel_hi:[1,0,1]
    v_pk_fma_f32 v[68:69], v[20:21], v[124:125], v[68:69] op_sel_hi:[1,0,1]
    v_pk_fma_f32 v[70:71], v[22:23], v[124:125], v[70:71] op_sel_hi:[1,0,1]
    v_pk_fma_f32 v[72:73], v[24:25], v[124:125], v[72:73] op_sel_hi:[1,0,1]
    v_pk_fma_f32 v[74:75], v[26:27], v[124:125], v[74:75] op_sel_hi:[1,0,1]
    v_pk_fma_f32 v[76:77], v[28:29], v[124:125], v[76:77] op_sel_hi:[1,0,1]
    v_pk_fma_f32 v[78:79], v[30:31], v[124:125], v[78:79] op_sel_hi:[1,0,1]
    v_cvt_pk_bf16_f32 v40, v64, v65
    v_cvt_pk_bf16_f32 v41, v66, v67
    v_cvt_pk_bf16_f32 v42, v68, v69
    v_cvt_pk_bf16_f32 v43, v70, v71
    v_cvt_pk_bf16_f32 v44, v72, v73
    v_cvt_pk_bf16_f32 v45, v74, v75
    v_cvt_pk_bf16_f32 v46, v76, v77
    v_cvt_pk_bf16_f32 v47, v78, v79
    v_xor_b32 v125, 64, v152
    ds_write_b64 v125, v[40:41]
    v_xor_b32 v126, 80, v152
    ds_write_b64 v126, v[42:43]
    v_xor_b32 v125, 96, v152
    ds_write_b64 v125, v[44:45]
    v_xor_b32 v126, 112, v152
    s_waitcnt lgkmcnt(12)
    ds_write_b64 v126, v[46:47]
    ds_read_b128 v[80:83], v153 offset:0
    ds_read_b128 v[84:87], v153 offset:1024
    s_waitcnt lgkmcnt(12)
    ds_read_b128 v[88:91], v153 offset:2048
    ds_read_b128 v[92:95], v153 offset:3072
    s_mov_b32 s46, 0
    s_waitcnt lgkmcnt(3)
    buffer_store_dwordx4 v[80:83], v148, s[16:19], s46 offen offset:0 nt
    s_mov_b32 s46, 2048
    s_waitcnt lgkmcnt(2)
    buffer_store_dwordx4 v[84:87], v148, s[16:19], s46 offen offset:0 nt
    s_mov_b32 s46, 4096
    s_waitcnt lgkmcnt(1)
    buffer_store_dwordx4 v[88:91], v148, s[16:19], s46 offen offset:0 nt
    s_mov_b32 s46, 6144
    s_waitcnt lgkmcnt(0)
    buffer_store_dwordx4 v[92:95], v148, s[16:19], s46 offen offset:0 nt
    v_min_f32 v120, v156, v158
    v_min3_f32 v120, v120, v160, v162
    v_sub_f32 v128, v120, v156
    v_sub_f32 v129, v120, v158
    v_sub_f32 v130, v120, v160
    v_sub_f32 v131, v120, v162
    v_exp_f32 v128, v128
    v_exp_f32 v129, v129
    v_exp_f32 v130, v130
    v_exp_f32 v131, v131
    v_mul_f32 v121, v128, v157
    v_fmac_f32 v121, v129, v159
    v_fmac_f32 v121, v130, v161
    v_fmac_f32 v121, v131, v163
    v_mov_b32 v123, v121
    s_nop 1
    v_permlane32_swap_b32 v121, v123
    v_add_f32 v121, v121, v123
    v_mov_b32 v123, v121
    s_nop 1
    v_permlane16_swap_b32 v121, v123
    v_add_f32 v121, v121, v123
    v_rcp_f32 v121, v121
    s_nop 0
    v_mul_f32 v128, v128, v121
    v_mul_f32 v129, v129, v121
    v_mul_f32 v130, v130, v121
    v_mul_f32 v131, v131, v121
    v_mul_f32 v164, v164, v128
    v_mul_f32 v165, v165, v128
    v_mul_f32 v166, v166, v128
    v_mul_f32 v167, v167, v128
    v_fmac_f32 v164, v168, v129
    v_fmac_f32 v165, v169, v129
    v_fmac_f32 v166, v170, v129
    v_fmac_f32 v167, v171, v129
    v_fmac_f32 v164, v172, v130
    v_fmac_f32 v165, v173, v130
    v_fmac_f32 v166, v174, v130
    v_fmac_f32 v167, v175, v130
    v_fmac_f32 v164, v176, v131
    v_fmac_f32 v165, v177, v131
    v_fmac_f32 v166, v178, v131
    v_fmac_f32 v167, v179, v131
    v_cvt_pk_bf16_f32 v132, v164, v165
    v_cvt_pk_bf16_f32 v133, v166, v167
    buffer_store_dwordx2 v[132:133], v146, s[16:19], 0 offen offset:0 nt
    s_endpgm
    s_nop 0
L_role1:
    v_lshlrev_b32 v8, 10, v4
    v_lshl_or_b32 v8, v5, 6, v8
    v_xor_b32 v9, v6, v4
    v_lshl_or_b32 v8, v9, 4, v8
    s_and_b32 s47, s20, 1
    s_lshl_b32 s47, s47, 13
    s_add_u32 s46, s47, 0x10000
    v_add_u32 v147, s46, v8
    v_lshlrev_b32 v8, 10, v6
    v_lshl_or_b32 v8, v4, 6, v8
    v_and_b32 v9, 1, v6
    v_lshl_or_b32 v8, v9, 5, v8
    v_lshl_or_b32 v8, v5, 3, v8
    v_add_u32 v148, s47, v8
    v_xor_b32 v149, 32, v148
    v_add_u32 v150, 0x20000, v150
    v_accvgpr_write_b32 a32, 0
    v_accvgpr_write_b32 a33, 0
    v_accvgpr_write_b32 a34, 0
    v_accvgpr_write_b32 a35, 0
    v_accvgpr_write_b32 a36, 0
    v_accvgpr_write_b32 a37, 0
    v_accvgpr_write_b32 a38, 0
    v_accvgpr_write_b32 a39, 0
    v_accvgpr_write_b32 a40, 0
    v_accvgpr_write_b32 a41, 0
    v_accvgpr_write_b32 a42, 0
    v_accvgpr_write_b32 a43, 0
    v_accvgpr_write_b32 a44, 0
    v_accvgpr_write_b32 a45, 0
    v_accvgpr_write_b32 a46, 0
    v_accvgpr_write_b32 a47, 0
    v_accvgpr_write_b32 a48, 0
    v_accvgpr_write_b32 a49, 0
    v_accvgpr_write_b32 a50, 0
    v_accvgpr_write_b32 a51, 0
    v_accvgpr_write_b32 a52, 0
    v_accvgpr_write_b32 a53, 0
    v_accvgpr_write_b32 a54, 0
    v_accvgpr_write_b32 a55, 0
    v_accvgpr_write_b32 a56, 0
    v_accvgpr_write_b32 a57, 0
    v_accvgpr_write_b32 a58, 0
    v_accvgpr_write_b32 a59, 0
    v_accvgpr_write_b32 a60, 0
    v_accvgpr_write_b32 a61, 0
    v_accvgpr_write_b32 a62, 0
    v_accvgpr_write_b32 a63, 0
    s_waitcnt vmcnt(12)
    v_lshlrev_b32 v16, 16, v112
    v_and_b32 v17, 0xffff0000, v112
    v_mul_f32 v16, s22, v16
    v_mul_f32 v17, s22, v17
    v_cvt_pk_bf16_f32 v112, v16, v17
    v_lshlrev_b32 v18, 16, v113
    v_and_b32 v19, 0xffff0000, v113
    v_mul_f32 v18, s22, v18
    v_mul_f32 v19, s22, v19
    v_cvt_pk_bf16_f32 v113, v18, v19
    v_lshlrev_b32 v20, 16, v114
    v_and_b32 v21, 0xffff0000, v114
    v_mul_f32 v20, s22, v20
    v_mul_f32 v21, s22, v21
    v_cvt_pk_bf16_f32 v114, v20, v21
    v_lshlrev_b32 v22, 16, v115
    v_and_b32 v23, 0xffff0000, v115
    v_mul_f32 v22, s22, v22
    v_mul_f32 v23, s22, v23
    v_cvt_pk_bf16_f32 v115, v22, v23
    s_lshl_b32 s46, s58, 10
    v_add_u32 v8, s46, v150
    ds_write_b128 v8, v[112:115]
    s_setprio 1
    s_waitcnt vmcnt(6) lgkmcnt(0)
    s_barrier
    ds_read_b128 v[156:159], v132 offset:0
    ds_read_b128 v[160:163], v133 offset:0
    ds_read_b128 v[164:167], v132 offset:256
    ds_read_b128 a[0:3], v144 offset:0
    s_waitcnt lgkmcnt(3)
    v_lshlrev_b32 v16, 16, v156
    v_and_b32 v17, 0xffff0000, v156
    v_lshlrev_b32 v18, 16, v157
    v_and_b32 v19, 0xffff0000, v157
    v_lshlrev_b32 v20, 16, v158
    v_and_b32 v21, 0xffff0000, v158
    v_lshlrev_b32 v22, 16, v159
    v_and_b32 v23, 0xffff0000, v159
    v_mul_f32 v16, s22, v16
    v_mul_f32 v17, s22, v17
    v_mul_f32 v18, s22, v18
    v_mul_f32 v19, s22, v19
    v_mul_f32 v20, s22, v20
    v_mul_f32 v21, s22, v21
    v_mul_f32 v22, s22, v22
    v_mul_f32 v23, s22, v23
    v_cvt_pk_bf16_f32 v156, v16, v17
    v_cvt_pk_bf16_f32 v157, v18, v19
    v_cvt_pk_bf16_f32 v158, v20, v21
    v_cvt_pk_bf16_f32 v159, v22, v23
    s_waitcnt lgkmcnt(0)
    s_nop 0
    v_mfma_f32_32x32x16_bf16 v[0:15], a[0:3], v[156:159], 0
    ds_read_b128 v[168:171], v133 offset:256
    ds_read_b128 a[4:7], v145 offset:0
    v_lshlrev_b32 v24, 16, v160
    v_and_b32 v25, 0xffff0000, v160
    v_lshlrev_b32 v26, 16, v161
    v_and_b32 v27, 0xffff0000, v161
    v_lshlrev_b32 v28, 16, v162
    v_and_b32 v29, 0xffff0000, v162
    v_lshlrev_b32 v30, 16, v163
    v_and_b32 v31, 0xffff0000, v163
    v_mul_f32 v24, s22, v24
    v_mul_f32 v25, s22, v25
    v_mul_f32 v26, s22, v26
    v_mul_f32 v27, s22, v27
    v_mul_f32 v28, s22, v28
    v_mul_f32 v29, s22, v29
    v_mul_f32 v30, s22, v30
    v_mul_f32 v31, s22, v31
    v_cvt_pk_bf16_f32 v160, v24, v25
    v_cvt_pk_bf16_f32 v161, v26, v27
    v_cvt_pk_bf16_f32 v162, v28, v29
    v_cvt_pk_bf16_f32 v163, v30, v31
    ds_read_b128 v[172:175], v132 offset:512
    s_waitcnt lgkmcnt(1)
    v_mfma_f32_32x32x16_bf16 v[0:15], a[4:7], v[160:163], v[0:15]
    ds_read_b128 a[8:11], v144 offset:256
    v_lshlrev_b32 v16, 16, v164
    v_and_b32 v17, 0xffff0000, v164
    v_lshlrev_b32 v18, 16, v165
    v_and_b32 v19, 0xffff0000, v165
    v_lshlrev_b32 v20, 16, v166
    v_and_b32 v21, 0xffff0000, v166
    v_lshlrev_b32 v22, 16, v167
    v_and_b32 v23, 0xffff0000, v167
    v_mul_f32 v16, s22, v16
    v_mul_f32 v17, s22, v17
    v_mul_f32 v18, s22, v18
    v_mul_f32 v19, s22, v19
    v_mul_f32 v20, s22, v20
    v_mul_f32 v21, s22, v21
    v_mul_f32 v22, s22, v22
    v_mul_f32 v23, s22, v23
    v_cvt_pk_bf16_f32 v164, v16, v17
    v_cvt_pk_bf16_f32 v165, v18, v19
    v_cvt_pk_bf16_f32 v166, v20, v21
    v_cvt_pk_bf16_f32 v167, v22, v23
    ds_read_b128 v[176:179], v133 offset:512
    ds_read_b128 v[180:183], v132 offset:768
    s_add_u32 s27, s26, 0x4000
    s_and_b32 s27, s27, 0x3ffff
    s_add_u32 s27, s27, s43
    s_add_u32 m0, s42, 0x4000
    s_add_u32 s44, s27, 0x0
    buffer_load_dwordx4 v152, s[8:11], s44 offen nt lds
    s_waitcnt lgkmcnt(2)
    v_mfma_f32_32x32x16_bf16 v[0:15], a[8:11], v[164:167], v[0:15]
    ds_read_b128 a[12:15], v145 offset:256
    v_lshlrev_b32 v24, 16, v168
    v_and_b32 v25, 0xffff0000, v168
    v_lshlrev_b32 v26, 16, v169
    v_and_b32 v27, 0xffff0000, v169
    v_lshlrev_b32 v28, 16, v170
    v_and_b32 v29, 0xffff0000, v170
    v_lshlrev_b32 v30, 16, v171
    v_and_b32 v31, 0xffff0000, v171
    v_mul_f32 v24, s22, v24
    v_mul_f32 v25, s22, v25
    v_mul_f32 v26, s22, v26
    v_mul_f32 v27, s22, v27
    v_mul_f32 v28, s22, v28
    v_mul_f32 v29, s22, v29
    v_mul_f32 v30, s22, v30
    v_mul_f32 v31, s22, v31
    v_cvt_pk_bf16_f32 v168, v24, v25
    v_cvt_pk_bf16_f32 v169, v26, v27
    v_cvt_pk_bf16_f32 v170, v28, v29
    v_cvt_pk_bf16_f32 v171, v30, v31
    ds_read_b128 v[184:187], v133 offset:768
    ds_read_b128 a[16:19], v144 offset:512
    s_waitcnt lgkmcnt(2)
    v_mfma_f32_32x32x16_bf16 v[0:15], a[12:15], v[168:171], v[0:15]
    v_lshlrev_b32 v16, 16, v172
    v_and_b32 v17, 0xffff0000, v172
    v_lshlrev_b32 v18, 16, v173
    v_and_b32 v19, 0xffff0000, v173
    v_lshlrev_b32 v20, 16, v174
    v_and_b32 v21, 0xffff0000, v174
    v_lshlrev_b32 v22, 16, v175
    v_and_b32 v23, 0xffff0000, v175
    v_mul_f32 v16, s22, v16
    v_mul_f32 v17, s22, v17
    v_mul_f32 v18, s22, v18
    v_mul_f32 v19, s22, v19
    v_mul_f32 v20, s22, v20
    v_mul_f32 v21, s22, v21
    v_mul_f32 v22, s22, v22
    v_mul_f32 v23, s22, v23
    v_cvt_pk_bf16_f32 v172, v16, v17
    v_cvt_pk_bf16_f32 v173, v18, v19
    v_cvt_pk_bf16_f32 v174, v20, v21
    v_cvt_pk_bf16_f32 v175, v22, v23
    ds_read_b128 a[20:23], v145 offset:512
    ds_read_b128 a[24:27], v144 offset:768
    ds_read_b128 a[28:31], v145 offset:768
    s_waitcnt lgkmcnt(3)
    v_mfma_f32_32x32x16_bf16 v[0:15], a[16:19], v[172:175], v[0:15]
    v_lshlrev_b32 v24, 16, v176
    v_and_b32 v25, 0xffff0000, v176
    v_lshlrev_b32 v26, 16, v177
    v_and_b32 v27, 0xffff0000, v177
    v_lshlrev_b32 v28, 16, v178
    v_and_b32 v29, 0xffff0000, v178
    v_lshlrev_b32 v30, 16, v179
    v_and_b32 v31, 0xffff0000, v179
    v_mul_f32 v24, s22, v24
    v_mul_f32 v25, s22, v25
    v_mul_f32 v26, s22, v26
    v_mul_f32 v27, s22, v27
    v_mul_f32 v28, s22, v28
    v_mul_f32 v29, s22, v29
    v_mul_f32 v30, s22, v30
    v_mul_f32 v31, s22, v31
    v_cvt_pk_bf16_f32 v176, v24, v25
    v_cvt_pk_bf16_f32 v177, v26, v27
    v_cvt_pk_bf16_f32 v178, v28, v29
    v_cvt_pk_bf16_f32 v179, v30, v31
    ds_read_b128 a[0:3], v147 offset:0
    ds_read_b128 a[4:7], v150 offset:0
    ds_read_b128 a[8:11], v147 offset:4096
    s_add_u32 m0, s42, 0x5000
    s_add_u32 s44, s27, 0x1000
    buffer_load_dwordx4 v152, s[8:11], s44 offen nt lds
    s_waitcnt lgkmcnt(3)
    v_mfma_f32_32x32x16_bf16 v[0:15], a[20:23], v[176:179], v[0:15]
    v_lshlrev_b32 v16, 16, v180
    v_and_b32 v17, 0xffff0000, v180
    v_lshlrev_b32 v18, 16, v181
    v_and_b32 v19, 0xffff0000, v181
    v_lshlrev_b32 v20, 16, v182
    v_and_b32 v21, 0xffff0000, v182
    v_lshlrev_b32 v22, 16, v183
    v_and_b32 v23, 0xffff0000, v183
    v_mul_f32 v16, s22, v16
    v_mul_f32 v17, s22, v17
    v_mul_f32 v18, s22, v18
    v_mul_f32 v19, s22, v19
    v_mul_f32 v20, s22, v20
    v_mul_f32 v21, s22, v21
    v_mul_f32 v22, s22, v22
    v_mul_f32 v23, s22, v23
    v_cvt_pk_bf16_f32 v180, v16, v17
    v_cvt_pk_bf16_f32 v181, v18, v19
    v_cvt_pk_bf16_f32 v182, v20, v21
    v_cvt_pk_bf16_f32 v183, v22, v23
    s_add_u32 s27, s26, 0xc000
    s_and_b32 s27, s27, 0x3ffff
    s_add_u32 s27, s27, s43
    s_add_u32 m0, s42, 0x1c000
    s_add_u32 s44, s27, 0x0
    buffer_load_dwordx4 v151, s[4:7], s44 offen nt lds
    s_add_u32 m0, s42, 0x1d000
    s_add_u32 s44, s27, 0x1000
    buffer_load_dwordx4 v151, s[4:7], s44 offen nt lds
    ds_read_b128 a[12:15], v147 offset:256
    ds_read_b128 a[16:19], v150 offset:1024
    v_mfma_f32_32x32x16_bf16 v[0:15], a[24:27], v[180:183], v[0:15]
    v_lshlrev_b32 v24, 16, v184
    v_and_b32 v25, 0xffff0000, v184
    v_lshlrev_b32 v26, 16, v185
    v_and_b32 v27, 0xffff0000, v185
    v_lshlrev_b32 v28, 16, v186
    v_and_b32 v29, 0xffff0000, v186
    v_lshlrev_b32 v30, 16, v187
    v_and_b32 v31, 0xffff0000, v187
    v_mul_f32 v24, s22, v24
    v_mul_f32 v25, s22, v25
    v_mul_f32 v26, s22, v26
    v_mul_f32 v27, s22, v27
    v_mul_f32 v28, s22, v28
    v_mul_f32 v29, s22, v29
    v_mul_f32 v30, s22, v30
    v_mul_f32 v31, s22, v31
    v_cvt_pk_bf16_f32 v184, v24, v25
    v_cvt_pk_bf16_f32 v185, v26, v27
    v_cvt_pk_bf16_f32 v186, v28, v29
    v_cvt_pk_bf16_f32 v187, v30, v31
    ds_read_b128 a[20:23], v147 offset:4352
    s_nop 0
    v_mfma_f32_32x32x16_bf16 v[0:15], a[28:31], v[184:187], v[0:15]
    ds_read_b128 a[24:27], v147 offset:512
    ds_read_b128 a[28:31], v150 offset:2048
    s_waitcnt lgkmcnt(3)
    v_mfma_f32_16x16x32_bf16 v[120:123], a[0:3], a[4:7], 0
    ds_read_b128 a[0:3], v147 offset:4608
    v_mfma_f32_16x16x32_bf16 v[124:127], a[8:11], a[4:7], 0
    ds_read_b128 a[4:7], v147 offset:768
    ds_read_b128 a[8:11], v150 offset:3072
    s_nop 3
    v_max3_f32 v134, v0, v1, v2
    v_max3_f32 v134, v134, v3, v4
    v_max3_f32 v134, v134, v5, v6
    v_max3_f32 v134, v134, v7, v8
    v_max3_f32 v134, v134, v9, v10
    v_max3_f32 v134, v134, v11, v12
    v_max3_f32 v134, v134, v13, v14
    v_max_f32 v134, v134, v15
    v_mov_b32 v135, v134
    s_nop 1
    v_permlane32_swap_b32 v134, v135
    v_max_f32 v134, v134, v135
    v_sub_f32 v0, v0, v134
    v_sub_f32 v1, v1, v134
    v_sub_f32 v2, v2, v134
    v_sub_f32 v3, v3, v134
    v_sub_f32 v4, v4, v134
    v_sub_f32 v5, v5, v134
    v_sub_f32 v6, v6, v134
    v_sub_f32 v7, v7, v134
    v_sub_f32 v8, v8, v134
    v_sub_f32 v9, v9, v134
    v_mfma_f32_16x16x32_bf16 v[120:123], a[12:15], a[16:19], v[120:123]
    ds_read_b128 a[12:15], v147 offset:4864
    v_sub_f32 v10, v10, v134
    v_sub_f32 v11, v11, v134
    v_sub_f32 v12, v12, v134
    v_sub_f32 v13, v13, v134
    v_sub_f32 v14, v14, v134
    v_sub_f32 v15, v15, v134
    v_sub_f32 v32, 0, v134
    v_sub_f32 v33, 0, v134
    s_waitcnt lgkmcnt(1)
    v_mfma_f32_16x16x32_bf16 v[124:127], a[20:23], a[16:19], v[124:127]
    v_sub_f32 v34, 0, v134
    v_sub_f32 v35, 0, v134
    v_sub_f32 v36, 0, v134
    v_sub_f32 v37, 0, v134
    v_sub_f32 v38, 0, v134
    v_sub_f32 v39, 0, v134
    v_sub_f32 v40, 0, v134
    v_sub_f32 v41, 0, v134
    v_mfma_f32_16x16x32_bf16 v[120:123], a[24:27], a[28:31], v[120:123]
    v_sub_f32 v42, 0, v134
    v_sub_f32 v43, 0, v134
    v_sub_f32 v44, 0, v134
    v_sub_f32 v45, 0, v134
    v_sub_f32 v46, 0, v134
    v_sub_f32 v47, 0, v134
    v_exp_f32 v132, v0
    v_mfma_f32_16x16x32_bf16 v[124:127], a[0:3], a[28:31], v[124:127]
    v_exp_f32 v133, v1
    s_nop 0
    v_add_f32 v141, v132, v133
    v_cvt_pk_bf16_f32 v112, v132, v133
    v_exp_f32 v134, v2
    v_exp_f32 v135, v3
    v_add_f32 v141, v141, v134
    v_mfma_f32_16x16x32_bf16 v[120:123], a[4:7], a[8:11], v[120:123]
    v_add_f32 v141, v141, v135
    v_cvt_pk_bf16_f32 v113, v134, v135
    v_exp_f32 v132, v4
    v_exp_f32 v133, v5
    v_add_f32 v141, v141, v132
    v_add_f32 v141, v141, v133
    v_cvt_pk_bf16_f32 v114, v132, v133
    v_exp_f32 v134, v6
    v_exp_f32 v135, v7
    v_add_f32 v141, v141, v134
    v_add_f32 v141, v141, v135
    v_cvt_pk_bf16_f32 v115, v134, v135
    s_waitcnt lgkmcnt(0)
    v_mfma_f32_16x16x32_bf16 v[124:127], a[12:15], a[8:11], v[124:127]
    s_waitcnt vmcnt(4)
    s_barrier
    ds_read_b128 a[0:3], v144 offset:16384
    s_waitcnt lgkmcnt(0)
    v_mfma_f32_32x32x16_bf16 v[16:31], a[0:3], v[156:159], v[32:47]
    ds_read_b128 a[4:7], v145 offset:16384
    ds_read_b128 a[8:11], v144 offset:16640
    ds_read_b128 a[12:15], v145 offset:16640
    v_exp_f32 v132, v8
    v_exp_f32 v133, v9
    v_add_f32 v141, v141, v132
    s_waitcnt lgkmcnt(2)
    v_mfma_f32_32x32x16_bf16 v[16:31], a[4:7], v[160:163], v[16:31]
    ds_read_b128 a[16:19], v144 offset:16896
    ds_read_b128 a[20:23], v145 offset:16896
    ds_read_b128 a[24:27], v144 offset:17152
    v_add_f32 v141, v141, v133
    v_cvt_pk_bf16_f32 v116, v132, v133
    v_exp_f32 v134, v10
    v_exp_f32 v135, v11
    s_waitcnt lgkmcnt(4)
    v_mfma_f32_32x32x16_bf16 v[16:31], a[8:11], v[164:167], v[16:31]
    ds_read_b128 a[28:31], v145 offset:17152
    v_add_f32 v141, v141, v134
    v_add_f32 v141, v141, v135
    v_cvt_pk_bf16_f32 v117, v134, v135
    v_exp_f32 v132, v12
    s_waitcnt lgkmcnt(3)
    v_mfma_f32_32x32x16_bf16 v[16:31], a[12:15], v[168:171], v[16:31]
    v_exp_f32 v133, v13
    v_add_f32 v141, v141, v132
    v_add_f32 v141, v141, v133
    v_cvt_pk_bf16_f32 v118, v132, v133
    v_max3_f32 v154, v120, v121, v122
    v_mfma_f32_32x32x16_bf16 v[16:31], a[16:19], v[172:175], v[16:31]
    ds_read_b64_tr_b16 a[0:1], v146 offset:0
    ds_read_b64_tr_b16 a[2:3], v146 offset:2048
    v_exp_f32 v134, v14
    v_exp_f32 v135, v15
    v_add_f32 v141, v141, v134
    s_waitcnt lgkmcnt(2)
    v_mfma_f32_32x32x16_bf16 v[16:31], a[20:23], v[176:179], v[16:31]
    ds_read_b64_tr_b16 a[4:5], v146 offset:256
    ds_read_b64_tr_b16 a[6:7], v146 offset:2304
    v_add_f32 v141, v141, v135
    v_cvt_pk_bf16_f32 v119, v134, v135
    v_cmp_nge_f32 vcc, 0x44800000, v141
    v_max3_f32 v154, v154, v123, v124
    v_max3_f32 v154, v154, v125, v126
    v_max_f32 v154, v154, v127
    v_mfma_f32_32x32x16_bf16 v[16:31], a[24:27], v[180:183], v[16:31]
    ds_read_b64_tr_b16 a[8:9], v146 offset:512
    ds_read_b64_tr_b16 a[10:11], v146 offset:2560
    v_mov_b32 v155, v154
    s_nop 1
    v_permlane32_swap_b32 v154, v155
    v_max_f32 v154, v154, v155
    v_mov_b32 v155, v154
    s_nop 1
    v_permlane16_swap_b32 v154, v155
    v_mfma_f32_32x32x16_bf16 v[16:31], a[28:31], v[184:187], v[16:31]
    ds_read_b64_tr_b16 a[12:13], v146 offset:768
    ds_read_b64_tr_b16 a[14:15], v146 offset:2816
    v_max_f32 v154, v154, v155
    v_sub_f32 v136, 0, v154
    v_sub_f32 v137, 0, v154
    v_sub_f32 v138, 0, v154
    v_sub_f32 v139, 0, v154
    v_sub_f32 v120, v120, v154
    s_cbranch_vccnz L_rc_25
L_rb_26:
    v_add_f32 v140, v140, v141
    ds_read_b64_tr_b16 a[16:17], v146 offset:4096
    ds_read_b64_tr_b16 a[18:19], v146 offset:6144
    s_waitcnt lgkmcnt(4)
    v_mfma_f32_32x32x16_bf16 v[48:63], a[0:3], v[112:115], v[48:63]
    ds_read_b64_tr_b16 a[20:21], v146 offset:4352
    ds_read_b64_tr_b16 a[22:23], v146 offset:6400
    v_sub_f32 v121, v121, v154
    v_sub_f32 v122, v122, v154
    v_sub_f32 v123, v123, v154
    v_sub_f32 v124, v124, v154
    v_sub_f32 v125, v125, v154
    v_mfma_f32_32x32x16_bf16 v[64:79], a[4:7], v[112:115], v[64:79]
    ds_read_b64_tr_b16 a[24:25], v146 offset:4608
    ds_read_b64_tr_b16 a[26:27], v146 offset:6656
    v_sub_f32 v126, v126, v154
    v_sub_f32 v127, v127, v154
    v_exp_f32 v154, v120
    v_exp_f32 v155, v121
    v_mfma_f32_32x32x16_bf16 v[80:95], a[8:11], v[112:115], v[80:95]
    ds_read_b64_tr_b16 a[28:29], v146 offset:4864
    ds_read_b64_tr_b16 a[30:31], v146 offset:6912
    v_add_f32 v143, v154, v155
    v_cvt_pk_bf16_f32 v128, v154, v155
    v_exp_f32 v154, v122
    v_exp_f32 v155, v123
    s_waitcnt lgkmcnt(4)
    v_mfma_f32_32x32x16_bf16 v[96:111], a[12:15], v[112:115], v[96:111]
    v_add_f32 v143, v143, v154
    v_add_f32 v143, v143, v155
    v_cvt_pk_bf16_f32 v129, v154, v155
    v_exp_f32 v154, v124
    v_mfma_f32_32x32x16_bf16 v[48:63], a[16:19], v[116:119], v[48:63]
    ds_read_b64_tr_b16 a[0:1], v148 offset:0
    ds_read_b64_tr_b16 a[2:3], v148 offset:4096
    v_exp_f32 v155, v125
    v_add_f32 v143, v143, v154
    v_add_f32 v143, v143, v155
    v_cvt_pk_bf16_f32 v130, v154, v155
    v_mfma_f32_32x32x16_bf16 v[64:79], a[20:23], v[116:119], v[64:79]
    ds_read_b64_tr_b16 a[4:5], v149 offset:0
    ds_read_b64_tr_b16 a[6:7], v149 offset:4096
    v_exp_f32 v154, v126
    v_exp_f32 v155, v127
    v_add_f32 v143, v143, v154
    v_add_f32 v143, v143, v155
    s_waitcnt lgkmcnt(4)
    v_mfma_f32_32x32x16_bf16 v[80:95], a[24:27], v[116:119], v[80:95]
    ds_read_b64_tr_b16 a[8:9], v148 offset:256
    ds_read_b64_tr_b16 a[10:11], v148 offset:4352
    v_cvt_pk_bf16_f32 v131, v154, v155
    v_exp_f32 v132, v16
    v_exp_f32 v133, v17
    v_mfma_f32_32x32x16_bf16 v[96:111], a[28:31], v[116:119], v[96:111]
    ds_read_b64_tr_b16 a[12:13], v149 offset:256
    ds_read_b64_tr_b16 a[14:15], v149 offset:4352
    v_add_f32 v141, v132, v133
    v_cvt_pk_bf16_f32 v112, v132, v133
    v_exp_f32 v134, v18
    v_exp_f32 v135, v19
    v_cmp_nge_f32 vcc, 0x44800000, v143
    s_cbranch_vccnz L_rc_27
L_rb_28:
    v_add_f32 v142, v142, v143
    ds_read_b64_tr_b16 a[16:17], v148 offset:512
    ds_read_b64_tr_b16 a[18:19], v148 offset:4608
    s_waitcnt lgkmcnt(4)
    v_mfma_f32_16x16x32_bf16 a[32:35], a[0:3], v[128:131], a[32:35]
    ds_read_b64_tr_b16 a[20:21], v149 offset:512
    ds_read_b64_tr_b16 a[22:23], v149 offset:4608
    v_add_f32 v141, v141, v134
    v_add_f32 v141, v141, v135
    v_mfma_f32_16x16x32_bf16 a[36:39], a[4:7], v[128:131], a[36:39]
    ds_read_b64_tr_b16 a[24:25], v148 offset:768
    ds_read_b64_tr_b16 a[26:27], v148 offset:4864
    v_cvt_pk_bf16_f32 v113, v134, v135
    v_mfma_f32_16x16x32_bf16 a[40:43], a[8:11], v[128:131], a[40:43]
    ds_read_b64_tr_b16 a[28:29], v149 offset:768
    ds_read_b64_tr_b16 a[30:31], v149 offset:4864
    v_exp_f32 v132, v20
    v_exp_f32 v133, v21
    s_waitcnt lgkmcnt(6)
    v_mfma_f32_16x16x32_bf16 a[44:47], a[12:15], v[128:131], a[44:47]
    ds_read_b128 a[0:3], v147 offset:32768
    ds_read_b128 a[4:7], v150 offset:0
    v_add_f32 v141, v141, v132
    v_mfma_f32_16x16x32_bf16 a[48:51], a[16:19], v[128:131], a[48:51]
    ds_read_b128 a[8:11], v147 offset:36864
    v_add_f32 v141, v141, v133
    v_cvt_pk_bf16_f32 v114, v132, v133
    s_waitcnt lgkmcnt(5)
    v_mfma_f32_16x16x32_bf16 a[52:55], a[20:23], v[128:131], a[52:55]
    ds_read_b128 a[12:15], v147 offset:33024
    v_exp_f32 v134, v22
    v_mfma_f32_16x16x32_bf16 a[56:59], a[24:27], v[128:131], a[56:59]
    v_exp_f32 v135, v23
    v_add_f32 v141, v141, v134
    v_add_f32 v141, v141, v135
    v_cvt_pk_bf16_f32 v115, v134, v135
    s_waitcnt lgkmcnt(2)
    v_mfma_f32_16x16x32_bf16 a[60:63], a[28:31], v[128:131], a[60:63]
    s_waitcnt vmcnt(0)
    s_barrier
L_loop1:
    s_waitcnt lgkmcnt(2)
    v_mfma_f32_16x16x32_bf16 v[120:123], a[0:3], a[4:7], v[136:139]
    ds_read_b128 a[16:19], v150 offset:1024
    ds_read_b128 a[20:23], v147 offset:37120
    ds_read_b128 a[24:27], v147 offset:33280
    v_exp_f32 v132, v24
    s_waitcnt lgkmcnt(4)
    v_mfma_f32_16x16x32_bf16 v[124:127], a[8:11], a[4:7], v[136:139]
    ds_read_b128 a[28:31], v150 offset:2048
    ds_read_b128 a[0:3], v147 offset:37376
    ds_read_b128 a[4:7], v147 offset:33536
    v_exp_f32 v133, v25
    s_waitcnt lgkmcnt(5)
    v_mfma_f32_16x16x32_bf16 v[120:123], a[12:15], a[16:19], v[120:123]
    ds_read_b128 a[8:11], v150 offset:3072
    ds_read_b128 a[12:15], v147 offset:37632
    v_add_f32 v141, v141, v132
    s_waitcnt lgkmcnt(6)
    v_mfma_f32_16x16x32_bf16 v[124:127], a[20:23], a[16:19], v[124:127]
    ds_read_b128 a[16:19], v144 offset:32768
    v_add_f32 v141, v141, v133
    v_cvt_pk_bf16_f32 v116, v132, v133
    s_waitcnt lgkmcnt(5)
    v_mfma_f32_16x16x32_bf16 v[120:123], a[24:27], a[28:31], v[120:123]
    ds_read_b128 a[20:23], v145 offset:32768
    v_exp_f32 v134, v26
    s_waitcnt lgkmcnt(4)
    v_mfma_f32_16x16x32_bf16 v[124:127], a[0:3], a[28:31], v[124:127]
    ds_read_b128 a[24:27], v144 offset:33024
    v_exp_f32 v135, v27
    s_waitcnt lgkmcnt(3)
    v_mfma_f32_16x16x32_bf16 v[120:123], a[4:7], a[8:11], v[120:123]
    ds_read_b128 a[28:31], v145 offset:33024
    v_add_f32 v141, v141, v134
    v_mfma_f32_16x16x32_bf16 v[124:127], a[12:15], a[8:11], v[124:127]
    ds_read_b128 a[0:3], v144 offset:33280
    v_add_f32 v141, v141, v135
    v_cvt_pk_bf16_f32 v117, v134, v135
    s_waitcnt lgkmcnt(3)
    v_mfma_f32_32x32x16_bf16 v[0:15], a[16:19], v[156:159], v[32:47]
    ds_read_b128 a[4:7], v145 offset:33280
    v_exp_f32 v132, v28
    v_exp_f32 v133, v29
    v_mfma_f32_32x32x16_bf16 v[0:15], a[20:23], v[160:163], v[0:15]
    ds_read_b128 a[8:11], v144 offset:33536
    v_add_f32 v141, v141, v132
    v_add_f32 v141, v141, v133
    v_cvt_pk_bf16_f32 v118, v132, v133
    v_exp_f32 v134, v30
    s_waitcnt lgkmcnt(2)
    v_mfma_f32_32x32x16_bf16 v[0:15], a[24:27], v[164:167], v[0:15]
    ds_read_b128 a[12:15], v145 offset:33536
    v_exp_f32 v135, v31
    v_add_f32 v141, v141, v134
    v_add_f32 v141, v141, v135
    v_mfma_f32_32x32x16_bf16 v[0:15], a[28:31], v[168:171], v[0:15]
    v_cvt_pk_bf16_f32 v119, v134, v135
    v_cmp_nge_f32 vcc, 0x44800000, v141
    v_exp_f32 v154, v120
    v_mfma_f32_32x32x16_bf16 v[0:15], a[0:3], v[172:175], v[0:15]
    ds_read_b64_tr_b16 a[16:17], v146 offset:16384
    ds_read_b64_tr_b16 a[18:19], v146 offset:18432
    v_exp_f32 v155, v121
    s_nop 0
    v_add_f32 v143, v154, v155
    v_cvt_pk_bf16_f32 v128, v154, v155
    s_waitcnt lgkmcnt(2)
    v_mfma_f32_32x32x16_bf16 v[0:15], a[4:7], v[176:179], v[0:15]
    ds_read_b64_tr_b16 a[20:21], v146 offset:16640
    ds_read_b64_tr_b16 a[22:23], v146 offset:18688
    v_exp_f32 v154, v122
    v_exp_f32 v155, v123
    v_add_f32 v143, v143, v154
    v_mfma_f32_32x32x16_bf16 v[0:15], a[8:11], v[180:183], v[0:15]
    ds_read_b64_tr_b16 a[24:25], v146 offset:16896
    ds_read_b64_tr_b16 a[26:27], v146 offset:18944
    v_add_f32 v143, v143, v155
    v_cvt_pk_bf16_f32 v129, v154, v155
    v_exp_f32 v154, v124
    v_mfma_f32_32x32x16_bf16 v[0:15], a[12:15], v[184:187], v[0:15]
    ds_read_b64_tr_b16 a[28:29], v146 offset:17152
    ds_read_b64_tr_b16 a[30:31], v146 offset:19200
    v_exp_f32 v155, v125
    v_add_f32 v143, v143, v154
    v_add_f32 v143, v143, v155
    s_cbranch_vccnz L_rc_41
L_rb_42:
    v_add_f32 v140, v140, v141
    ds_read_b64_tr_b16 a[0:1], v146 offset:20480
    ds_read_b64_tr_b16 a[2:3], v146 offset:22528
    s_waitcnt lgkmcnt(4)
    v_mfma_f32_32x32x16_bf16 v[48:63], a[16:19], v[112:115], v[48:63]
    ds_read_b64_tr_b16 a[4:5], v146 offset:20736
    ds_read_b64_tr_b16 a[6:7], v146 offset:22784
    v_exp_f32 v132, v0
    v_exp_f32 v133, v1
    s_nop 0
    v_add_f32 v141, v132, v133
    v_mfma_f32_32x32x16_bf16 v[64:79], a[20:23], v[112:115], v[64:79]
    ds_read_b64_tr_b16 a[8:9], v146 offset:20992
    ds_read_b64_tr_b16 a[10:11], v146 offset:23040
    v_cvt_pk_bf16_f32 v130, v154, v155
    v_exp_f32 v154, v126
    v_exp_f32 v155, v127
    v_mfma_f32_32x32x16_bf16 v[80:95], a[24:27], v[112:115], v[80:95]
    ds_read_b64_tr_b16 a[12:13], v146 offset:21248
    ds_read_b64_tr_b16 a[14:15], v146 offset:23296
    v_add_f32 v143, v143, v154
    v_add_f32 v143, v143, v155
    v_cvt_pk_bf16_f32 v131, v154, v155
    s_waitcnt lgkmcnt(4)
    v_mfma_f32_32x32x16_bf16 v[96:111], a[28:31], v[112:115], v[96:111]
    v_cvt_pk_bf16_f32 v112, v132, v133
    v_exp_f32 v134, v2
    v_exp_f32 v135, v3
    v_mfma_f32_32x32x16_bf16 v[48:63], a[0:3], v[116:119], v[48:63]
    ds_read_b128 a[0:3], v144 offset:49152
    v_add_f32 v141, v141, v134
    v_add_f32 v141, v141, v135
    v_cvt_pk_bf16_f32 v113, v134, v135
    v_exp_f32 v132, v4
    v_mfma_f32_32x32x16_bf16 v[64:79], a[4:7], v[116:119], v[64:79]
    ds_read_b128 a[4:7], v145 offset:49152
    v_exp_f32 v133, v5
    v_add_f32 v141, v141, v132
    s_waitcnt lgkmcnt(2)
    v_mfma_f32_32x32x16_bf16 v[80:95], a[8:11], v[116:119], v[80:95]
    ds_read_b128 a[8:11], v144 offset:49408
    v_add_f32 v141, v141, v133
    v_cvt_pk_bf16_f32 v114, v132, v133
    v_exp_f32 v134, v6
    v_exp_f32 v135, v7
    v_add_f32 v141, v141, v134
    v_add_f32 v141, v141, v135
    v_cvt_pk_bf16_f32 v115, v134, v135
    v_mfma_f32_32x32x16_bf16 v[96:111], a[12:15], v[116:119], v[96:111]
    ds_read_b128 a[12:15], v145 offset:49408
    v_cmp_nge_f32 vcc, 0x44800000, v143
    s_cbranch_vccnz L_rc_43
L_rb_44:
    v_add_f32 v142, v142, v143
    s_barrier
    s_waitcnt lgkmcnt(1)
    v_mfma_f32_32x32x16_bf16 v[16:31], a[0:3], v[156:159], v[32:47]
    ds_read_b128 a[16:19], v144 offset:49664
    ds_read_b128 a[20:23], v145 offset:49664
    v_exp_f32 v132, v8
    v_mfma_f32_32x32x16_bf16 v[16:31], a[4:7], v[160:163], v[16:31]
    ds_read_b128 a[24:27], v144 offset:49920
    v_exp_f32 v133, v9
    v_add_f32 v141, v141, v132
    v_add_f32 v141, v141, v133
    v_mfma_f32_32x32x16_bf16 v[16:31], a[8:11], v[164:167], v[16:31]
    ds_read_b128 a[28:31], v145 offset:49920
    v_cvt_pk_bf16_f32 v116, v132, v133
    v_exp_f32 v134, v10
    s_waitcnt lgkmcnt(4)
    v_mfma_f32_32x32x16_bf16 v[16:31], a[12:15], v[168:171], v[16:31]
    v_exp_f32 v135, v11
    v_add_f32 v141, v141, v134
    s_waitcnt lgkmcnt(2)
    v_mfma_f32_32x32x16_bf16 v[16:31], a[16:19], v[172:175], v[16:31]
    ds_read_b64_tr_b16 a[0:1], v146 offset:32768
    ds_read_b64_tr_b16 a[2:3], v146 offset:34816
    v_add_f32 v141, v141, v135
    v_cvt_pk_bf16_f32 v117, v134, v135
    v_mfma_f32_32x32x16_bf16 v[16:31], a[20:23], v[176:179], v[16:31]
    ds_read_b64_tr_b16 a[4:5], v146 offset:33024
    ds_read_b64_tr_b16 a[6:7], v146 offset:35072
    v_exp_f32 v132, v12
    v_exp_f32 v133, v13
    s_waitcnt lgkmcnt(4)
    v_mfma_f32_32x32x16_bf16 v[16:31], a[24:27], v[180:183], v[16:31]
    ds_read_b64_tr_b16 a[8:9], v146 offset:33280
    ds_read_b64_tr_b16 a[10:11], v146 offset:35328
    v_add_f32 v141, v141, v132
    v_add_f32 v141, v141, v133
    v_mfma_f32_32x32x16_bf16 v[16:31], a[28:31], v[184:187], v[16:31]
    v_cvt_pk_bf16_f32 v118, v132, v133
    v_exp_f32 v134, v14
    v_exp_f32 v135, v15
    v_add_f32 v141, v141, v134
    v_add_f32 v141, v141, v135
    v_cvt_pk_bf16_f32 v119, v134, v135
    v_cmp_nge_f32 vcc, 0x44800000, v141
    ds_read_b64_tr_b16 a[12:13], v146 offset:33536
    ds_read_b64_tr_b16 a[14:15], v146 offset:35584
    s_cbranch_vccnz L_rc_45
L_rb_46:
    v_add_f32 v140, v140, v141
    ds_read_b64_tr_b16 a[16:17], v146 offset:36864
    ds_read_b64_tr_b16 a[18:19], v146 offset:38912
    s_waitcnt lgkmcnt(4)
    v_mfma_f32_32x32x16_bf16 v[48:63], a[0:3], v[112:115], v[48:63]
    ds_read_b64_tr_b16 a[20:21], v146 offset:37120
    ds_read_b64_tr_b16 a[22:23], v146 offset:39168
    v_mfma_f32_32x32x16_bf16 v[64:79], a[4:7], v[112:115], v[64:79]
    ds_read_b64_tr_b16 a[24:25], v146 offset:37376
    ds_read_b64_tr_b16 a[26:27], v146 offset:39424
    v_mfma_f32_32x32x16_bf16 v[80:95], a[8:11], v[112:115], v[80:95]
    ds_read_b64_tr_b16 a[28:29], v146 offset:37632
    ds_read_b64_tr_b16 a[30:31], v146 offset:39680
    v_exp_f32 v132, v16
    v_exp_f32 v133, v17
    s_waitcnt lgkmcnt(7)
    v_mfma_f32_32x32x16_bf16 v[96:111], a[12:15], v[112:115], v[96:111]
    ds_read_b64_tr_b16 a[0:1], v148 offset:32768
    ds_read_b64_tr_b16 a[2:3], v148 offset:36864
    v_add_f32 v141, v132, v133
    v_cvt_pk_bf16_f32 v112, v132, v133
    s_waitcnt lgkmcnt(6)
    v_mfma_f32_32x32x16_bf16 v[48:63], a[16:19], v[116:119], v[48:63]
    ds_read_b64_tr_b16 a[4:5], v149 offset:32768
    ds_read_b64_tr_b16 a[6:7], v149 offset:36864
    v_exp_f32 v134, v18
    v_mfma_f32_32x32x16_bf16 v[64:79], a[20:23], v[116:119], v[64:79]
    ds_read_b64_tr_b16 a[8:9], v148 offset:33024
    ds_read_b64_tr_b16 a[10:11], v148 offset:37120
    v_exp_f32 v135, v19
    v_add_f32 v141, v141, v134
    v_add_f32 v141, v141, v135
    s_waitcnt lgkmcnt(4)
    v_mfma_f32_32x32x16_bf16 v[80:95], a[24:27], v[116:119], v[80:95]
    ds_read_b64_tr_b16 a[12:13], v149 offset:33024
    ds_read_b64_tr_b16 a[14:15], v149 offset:37120
    v_cvt_pk_bf16_f32 v113, v134, v135
    v_exp_f32 v132, v20
    v_mfma_f32_32x32x16_bf16 v[96:111], a[28:31], v[116:119], v[96:111]
    ds_read_b64_tr_b16 a[16:17], v148 offset:33280
    ds_read_b64_tr_b16 a[18:19], v148 offset:37376
    v_exp_f32 v133, v21
    v_add_f32 v141, v141, v132
    v_mfma_f32_16x16x32_bf16 a[32:35], a[0:3], v[128:131], a[32:35]
    ds_read_b64_tr_b16 a[20:21], v149 offset:33280
    ds_read_b64_tr_b16 a[22:23], v149 offset:37376
    v_add_f32 v141, v141, v133
    s_waitcnt lgkmcnt(6)
    v_mfma_f32_16x16x32_bf16 a[36:39], a[4:7], v[128:131], a[36:39]
    ds_read_b64_tr_b16 a[24:25], v148 offset:33536
    ds_read_b64_tr_b16 a[26:27], v148 offset:37632
    v_cvt_pk_bf16_f32 v114, v132, v133
    v_mfma_f32_16x16x32_bf16 a[40:43], a[8:11], v[128:131], a[40:43]
    ds_read_b64_tr_b16 a[28:29], v149 offset:33536
    ds_read_b64_tr_b16 a[30:31], v149 offset:37632
    v_exp_f32 v134, v22
    s_waitcnt lgkmcnt(6)
    v_mfma_f32_16x16x32_bf16 a[44:47], a[12:15], v[128:131], a[44:47]
    ds_read_b128 a[0:3], v147 offset:0
    ds_read_b128 a[4:7], v150 offset:0
    v_mfma_f32_16x16x32_bf16 a[48:51], a[16:19], v[128:131], a[48:51]
    ds_read_b128 a[8:11], v147 offset:4096
    v_exp_f32 v135, v23
    s_waitcnt lgkmcnt(6)
    v_mfma_f32_16x16x32_bf16 a[52:55], a[20:23], v[128:131], a[52:55]
    ds_read_b128 a[12:15], v147 offset:256
    v_add_f32 v141, v141, v134
    s_waitcnt lgkmcnt(5)
    v_mfma_f32_16x16x32_bf16 a[56:59], a[24:27], v[128:131], a[56:59]
    v_add_f32 v141, v141, v135
    v_cvt_pk_bf16_f32 v115, v134, v135
    s_waitcnt lgkmcnt(4)
    v_mfma_f32_16x16x32_bf16 a[60:63], a[28:31], v[128:131], a[60:63]
    s_barrier
    s_waitcnt lgkmcnt(2)
    v_mfma_f32_16x16x32_bf16 v[120:123], a[0:3], a[4:7], v[136:139]
    ds_read_b128 a[16:19], v150 offset:1024
    ds_read_b128 a[20:23], v147 offset:4352
    ds_read_b128 a[24:27], v147 offset:512
    v_exp_f32 v132, v24
    s_waitcnt lgkmcnt(3)
    v_mfma_f32_16x16x32_bf16 v[124:127], a[8:11], a[4:7], v[136:139]
    ds_read_b128 a[28:31], v150 offset:2048
    ds_read_b128 a[0:3], v147 offset:4608
    ds_read_b128 a[4:7], v147 offset:768
    v_exp_f32 v133, v25
    s_waitcnt lgkmcnt(5)
    v_mfma_f32_16x16x32_bf16 v[120:123], a[12:15], a[16:19], v[120:123]
    ds_read_b128 a[8:11], v150 offset:3072
    ds_read_b128 a[12:15], v147 offset:4864
    v_add_f32 v141, v141, v132
    s_waitcnt lgkmcnt(6)
    v_mfma_f32_16x16x32_bf16 v[124:127], a[20:23], a[16:19], v[124:127]
    ds_read_b128 a[16:19], v144 offset:0
    v_add_f32 v141, v141, v133
    v_cvt_pk_bf16_f32 v116, v132, v133
    s_waitcnt lgkmcnt(5)
    v_mfma_f32_16x16x32_bf16 v[120:123], a[24:27], a[28:31], v[120:123]
    ds_read_b128 a[20:23], v145 offset:0
    v_exp_f32 v134, v26
    s_waitcnt lgkmcnt(4)
    v_mfma_f32_16x16x32_bf16 v[124:127], a[0:3], a[28:31], v[124:127]
    ds_read_b128 a[24:27], v144 offset:256
    v_exp_f32 v135, v27
    s_waitcnt lgkmcnt(3)
    v_mfma_f32_16x16x32_bf16 v[120:123], a[4:7], a[8:11], v[120:123]
    ds_read_b128 a[28:31], v145 offset:256
    v_add_f32 v141, v141, v134
    v_mfma_f32_16x16x32_bf16 v[124:127], a[12:15], a[8:11], v[124:127]
    ds_read_b128 a[0:3], v144 offset:512
    v_add_f32 v141, v141, v135
    v_cvt_pk_bf16_f32 v117, v134, v135
    s_waitcnt lgkmcnt(3)
    v_mfma_f32_32x32x16_bf16 v[0:15], a[16:19], v[156:159], v[32:47]
    ds_read_b128 a[4:7], v145 offset:512
    v_exp_f32 v132, v28
    v_exp_f32 v133, v29
    v_mfma_f32_32x32x16_bf16 v[0:15], a[20:23], v[160:163], v[0:15]
    ds_read_b128 a[8:11], v144 offset:768
    v_add_f32 v141, v141, v132
    v_add_f32 v141, v141, v133
    v_cvt_pk_bf16_f32 v118, v132, v133
    v_exp_f32 v134, v30
    s_waitcnt lgkmcnt(2)
    v_mfma_f32_32x32x16_bf16 v[0:15], a[24:27], v[164:167], v[0:15]
    ds_read_b128 a[12:15], v145 offset:768
    v_exp_f32 v135, v31
    v_add_f32 v141, v141, v134
    v_add_f32 v141, v141, v135
    v_mfma_f32_32x32x16_bf16 v[0:15], a[28:31], v[168:171], v[0:15]
    v_cvt_pk_bf16_f32 v119, v134, v135
    v_cmp_nge_f32 vcc, 0x44800000, v141
    v_exp_f32 v154, v120
    v_mfma_f32_32x32x16_bf16 v[0:15], a[0:3], v[172:175], v[0:15]
    ds_read_b64_tr_b16 a[16:17], v146 offset:49152
    ds_read_b64_tr_b16 a[18:19], v146 offset:51200
    v_exp_f32 v155, v121
    s_nop 0
    v_add_f32 v143, v154, v155
    v_cvt_pk_bf16_f32 v128, v154, v155
    s_waitcnt lgkmcnt(2)
    v_mfma_f32_32x32x16_bf16 v[0:15], a[4:7], v[176:179], v[0:15]
    ds_read_b64_tr_b16 a[20:21], v146 offset:49408
    ds_read_b64_tr_b16 a[22:23], v146 offset:51456
    v_exp_f32 v154, v122
    v_exp_f32 v155, v123
    v_add_f32 v143, v143, v154
    v_mfma_f32_32x32x16_bf16 v[0:15], a[8:11], v[180:183], v[0:15]
    ds_read_b64_tr_b16 a[24:25], v146 offset:49664
    ds_read_b64_tr_b16 a[26:27], v146 offset:51712
    v_add_f32 v143, v143, v155
    v_cvt_pk_bf16_f32 v129, v154, v155
    v_exp_f32 v154, v124
    v_mfma_f32_32x32x16_bf16 v[0:15], a[12:15], v[184:187], v[0:15]
    ds_read_b64_tr_b16 a[28:29], v146 offset:49920
    ds_read_b64_tr_b16 a[30:31], v146 offset:51968
    v_exp_f32 v155, v125
    v_add_f32 v143, v143, v154
    v_add_f32 v143, v143, v155
    s_cbranch_vccnz L_rc_47
L_rb_48:
    v_add_f32 v140, v140, v141
    ds_read_b64_tr_b16 a[0:1], v146 offset:53248
    ds_read_b64_tr_b16 a[2:3], v146 offset:55296
    s_waitcnt lgkmcnt(4)
    v_mfma_f32_32x32x16_bf16 v[48:63], a[16:19], v[112:115], v[48:63]
    ds_read_b64_tr_b16 a[4:5], v146 offset:53504
    ds_read_b64_tr_b16 a[6:7], v146 offset:55552
    v_exp_f32 v132, v0
    v_exp_f32 v133, v1
    s_nop 0
    v_add_f32 v141, v132, v133
    v_mfma_f32_32x32x16_bf16 v[64:79], a[20:23], v[112:115], v[64:79]
    ds_read_b64_tr_b16 a[8:9], v146 offset:53760
    ds_read_b64_tr_b16 a[10:11], v146 offset:55808
    v_cvt_pk_bf16_f32 v130, v154, v155
    v_exp_f32 v154, v126
    v_exp_f32 v155, v127
    v_mfma_f32_32x32x16_bf16 v[80:95], a[24:27], v[112:115], v[80:95]
    ds_read_b64_tr_b16 a[12:13], v146 offset:54016
    ds_read_b64_tr_b16 a[14:15], v146 offset:56064
    v_add_f32 v143, v143, v154
    v_add_f32 v143, v143, v155
    v_cvt_pk_bf16_f32 v131, v154, v155
    s_waitcnt lgkmcnt(4)
    v_mfma_f32_32x32x16_bf16 v[96:111], a[28:31], v[112:115], v[96:111]
    v_cvt_pk_bf16_f32 v112, v132, v133
    v_exp_f32 v134, v2
    v_exp_f32 v135, v3
    v_mfma_f32_32x32x16_bf16 v[48:63], a[0:3], v[116:119], v[48:63]
    ds_read_b128 a[0:3], v144 offset:16384
    v_add_f32 v141, v141, v134
    v_add_f32 v141, v141, v135
    v_cvt_pk_bf16_f32 v113, v134, v135
    v_exp_f32 v132, v4
    v_mfma_f32_32x32x16_bf16 v[64:79], a[4:7], v[116:119], v[64:79]
    ds_read_b128 a[4:7], v145 offset:16384
    v_exp_f32 v133, v5
    v_add_f32 v141, v141, v132
    s_waitcnt lgkmcnt(2)
    v_mfma_f32_32x32x16_bf16 v[80:95], a[8:11], v[116:119], v[80:95]
    ds_read_b128 a[8:11], v144 offset:16640
    v_add_f32 v141, v141, v133
    v_cvt_pk_bf16_f32 v114, v132, v133
    v_exp_f32 v134, v6
    v_exp_f32 v135, v7
    v_add_f32 v141, v141, v134
    v_add_f32 v141, v141, v135
    v_cvt_pk_bf16_f32 v115, v134, v135
    v_mfma_f32_32x32x16_bf16 v[96:111], a[12:15], v[116:119], v[96:111]
    ds_read_b128 a[12:15], v145 offset:16640
    v_cmp_nge_f32 vcc, 0x44800000, v143
    s_cbranch_vccnz L_rc_49
L_rb_50:
    v_add_f32 v142, v142, v143
    s_barrier
    s_waitcnt lgkmcnt(1)
    v_mfma_f32_32x32x16_bf16 v[16:31], a[0:3], v[156:159], v[32:47]
    ds_read_b128 a[16:19], v144 offset:16896
    ds_read_b128 a[20:23], v145 offset:16896
    v_exp_f32 v132, v8
    v_mfma_f32_32x32x16_bf16 v[16:31], a[4:7], v[160:163], v[16:31]
    ds_read_b128 a[24:27], v144 offset:17152
    v_exp_f32 v133, v9
    v_add_f32 v141, v141, v132
    v_add_f32 v141, v141, v133
    v_mfma_f32_32x32x16_bf16 v[16:31], a[8:11], v[164:167], v[16:31]
    ds_read_b128 a[28:31], v145 offset:17152
    v_cvt_pk_bf16_f32 v116, v132, v133
    v_exp_f32 v134, v10
    s_waitcnt lgkmcnt(4)
    v_mfma_f32_32x32x16_bf16 v[16:31], a[12:15], v[168:171], v[16:31]
    v_exp_f32 v135, v11
    v_add_f32 v141, v141, v134
    s_waitcnt lgkmcnt(2)
    v_mfma_f32_32x32x16_bf16 v[16:31], a[16:19], v[172:175], v[16:31]
    ds_read_b64_tr_b16 a[0:1], v146 offset:0
    ds_read_b64_tr_b16 a[2:3], v146 offset:2048
    v_add_f32 v141, v141, v135
    v_cvt_pk_bf16_f32 v117, v134, v135
    v_mfma_f32_32x32x16_bf16 v[16:31], a[20:23], v[176:179], v[16:31]
    ds_read_b64_tr_b16 a[4:5], v146 offset:256
    ds_read_b64_tr_b16 a[6:7], v146 offset:2304
    v_exp_f32 v132, v12
    v_exp_f32 v133, v13
    s_waitcnt lgkmcnt(4)
    v_mfma_f32_32x32x16_bf16 v[16:31], a[24:27], v[180:183], v[16:31]
    ds_read_b64_tr_b16 a[8:9], v146 offset:512
    ds_read_b64_tr_b16 a[10:11], v146 offset:2560
    v_add_f32 v141, v141, v132
    v_add_f32 v141, v141, v133
    v_mfma_f32_32x32x16_bf16 v[16:31], a[28:31], v[184:187], v[16:31]
    v_cvt_pk_bf16_f32 v118, v132, v133
    v_exp_f32 v134, v14
    v_exp_f32 v135, v15
    v_add_f32 v141, v141, v134
    v_add_f32 v141, v141, v135
    v_cvt_pk_bf16_f32 v119, v134, v135
    v_cmp_nge_f32 vcc, 0x44800000, v141
    ds_read_b64_tr_b16 a[12:13], v146 offset:768
    ds_read_b64_tr_b16 a[14:15], v146 offset:2816
    s_cbranch_vccnz L_rc_51
L_rb_52:
    v_add_f32 v140, v140, v141
    ds_read_b64_tr_b16 a[16:17], v146 offset:4096
    ds_read_b64_tr_b16 a[18:19], v146 offset:6144
    s_waitcnt lgkmcnt(4)
    v_mfma_f32_32x32x16_bf16 v[48:63], a[0:3], v[112:115], v[48:63]
    ds_read_b64_tr_b16 a[20:21], v146 offset:4352
    ds_read_b64_tr_b16 a[22:23], v146 offset:6400
    v_mfma_f32_32x32x16_bf16 v[64:79], a[4:7], v[112:115], v[64:79]
    ds_read_b64_tr_b16 a[24:25], v146 offset:4608
    ds_read_b64_tr_b16 a[26:27], v146 offset:6656
    v_mfma_f32_32x32x16_bf16 v[80:95], a[8:11], v[112:115], v[80:95]
    ds_read_b64_tr_b16 a[28:29], v146 offset:4864
    ds_read_b64_tr_b16 a[30:31], v146 offset:6912
    v_exp_f32 v132, v16
    v_exp_f32 v133, v17
    s_waitcnt lgkmcnt(7)
    v_mfma_f32_32x32x16_bf16 v[96:111], a[12:15], v[112:115], v[96:111]
    ds_read_b64_tr_b16 a[0:1], v148 offset:0
    ds_read_b64_tr_b16 a[2:3], v148 offset:4096
    v_add_f32 v141, v132, v133
    v_cvt_pk_bf16_f32 v112, v132, v133
    s_waitcnt lgkmcnt(6)
    v_mfma_f32_32x32x16_bf16 v[48:63], a[16:19], v[116:119], v[48:63]
    ds_read_b64_tr_b16 a[4:5], v149 offset:0
    ds_read_b64_tr_b16 a[6:7], v149 offset:4096
    v_exp_f32 v134, v18
    v_mfma_f32_32x32x16_bf16 v[64:79], a[20:23], v[116:119], v[64:79]
    ds_read_b64_tr_b16 a[8:9], v148 offset:256
    ds_read_b64_tr_b16 a[10:11], v148 offset:4352
    v_exp_f32 v135, v19
    v_add_f32 v141, v141, v134
    v_add_f32 v141, v141, v135
    s_waitcnt lgkmcnt(4)
    v_mfma_f32_32x32x16_bf16 v[80:95], a[24:27], v[116:119], v[80:95]
    ds_read_b64_tr_b16 a[12:13], v149 offset:256
    ds_read_b64_tr_b16 a[14:15], v149 offset:4352
    v_cvt_pk_bf16_f32 v113, v134, v135
    v_exp_f32 v132, v20
    v_mfma_f32_32x32x16_bf16 v[96:111], a[28:31], v[116:119], v[96:111]
    ds_read_b64_tr_b16 a[16:17], v148 offset:512
    ds_read_b64_tr_b16 a[18:19], v148 offset:4608
    v_exp_f32 v133, v21
    v_add_f32 v141, v141, v132
    v_mfma_f32_16x16x32_bf16 a[32:35], a[0:3], v[128:131], a[32:35]
    ds_read_b64_tr_b16 a[20:21], v149 offset:512
    ds_read_b64_tr_b16 a[22:23], v149 offset:4608
    v_add_f32 v141, v141, v133
    s_waitcnt lgkmcnt(6)
    v_mfma_f32_16x16x32_bf16 a[36:39], a[4:7], v[128:131], a[36:39]
    ds_read_b64_tr_b16 a[24:25], v148 offset:768
    ds_read_b64_tr_b16 a[26:27], v148 offset:4864
    v_cvt_pk_bf16_f32 v114, v132, v133
    v_mfma_f32_16x16x32_bf16 a[40:43], a[8:11], v[128:131], a[40:43]
    ds_read_b64_tr_b16 a[28:29], v149 offset:768
    ds_read_b64_tr_b16 a[30:31], v149 offset:4864
    v_exp_f32 v134, v22
    s_waitcnt lgkmcnt(6)
    v_mfma_f32_16x16x32_bf16 a[44:47], a[12:15], v[128:131], a[44:47]
    ds_read_b128 a[0:3], v147 offset:32768
    ds_read_b128 a[4:7], v150 offset:0
    v_mfma_f32_16x16x32_bf16 a[48:51], a[16:19], v[128:131], a[48:51]
    ds_read_b128 a[8:11], v147 offset:36864
    v_exp_f32 v135, v23
    s_waitcnt lgkmcnt(6)
    v_mfma_f32_16x16x32_bf16 a[52:55], a[20:23], v[128:131], a[52:55]
    ds_read_b128 a[12:15], v147 offset:33024
    v_add_f32 v141, v141, v134
    s_waitcnt lgkmcnt(5)
    v_mfma_f32_16x16x32_bf16 a[56:59], a[24:27], v[128:131], a[56:59]
    v_add_f32 v141, v141, v135
    v_cvt_pk_bf16_f32 v115, v134, v135
    s_waitcnt lgkmcnt(4)
    v_mfma_f32_16x16x32_bf16 a[60:63], a[28:31], v[128:131], a[60:63]
    s_barrier
    s_sub_u32 s21, s21, 1
    s_cmp_lg_u32 s21, 0
    s_cbranch_scc1 L_loop1
    s_waitcnt lgkmcnt(1)
    v_mfma_f32_16x16x32_bf16 v[120:123], a[0:3], a[4:7], v[136:139]
    ds_read_b128 a[16:19], v150 offset:1024
    ds_read_b128 a[20:23], v147 offset:37120
    ds_read_b128 a[24:27], v147 offset:33280
    v_exp_f32 v132, v24
    v_mfma_f32_16x16x32_bf16 v[124:127], a[8:11], a[4:7], v[136:139]
    ds_read_b128 a[28:31], v150 offset:2048
    ds_read_b128 a[0:3], v147 offset:37376
    ds_read_b128 a[4:7], v147 offset:33536
    v_exp_f32 v133, v25
    s_waitcnt lgkmcnt(5)
    v_mfma_f32_16x16x32_bf16 v[120:123], a[12:15], a[16:19], v[120:123]
    ds_read_b128 a[8:11], v150 offset:3072
    ds_read_b128 a[12:15], v147 offset:37632
    v_add_f32 v141, v141, v132
    s_waitcnt lgkmcnt(6)
    v_mfma_f32_16x16x32_bf16 v[124:127], a[20:23], a[16:19], v[124:127]
    ds_read_b128 a[16:19], v144 offset:32768
    v_add_f32 v141, v141, v133
    v_cvt_pk_bf16_f32 v116, v132, v133
    s_waitcnt lgkmcnt(5)
    v_mfma_f32_16x16x32_bf16 v[120:123], a[24:27], a[28:31], v[120:123]
    ds_read_b128 a[20:23], v145 offset:32768
    v_exp_f32 v134, v26
    s_waitcnt lgkmcnt(4)
    v_mfma_f32_16x16x32_bf16 v[124:127], a[0:3], a[28:31], v[124:127]
    ds_read_b128 a[24:27], v144 offset:33024
    v_exp_f32 v135, v27
    s_waitcnt lgkmcnt(3)
    v_mfma_f32_16x16x32_bf16 v[120:123], a[4:7], a[8:11], v[120:123]
    ds_read_b128 a[28:31], v145 offset:33024
    v_add_f32 v141, v141, v134
    v_mfma_f32_16x16x32_bf16 v[124:127], a[12:15], a[8:11], v[124:127]
    ds_read_b128 a[0:3], v144 offset:33280
    v_add_f32 v141, v141, v135
    v_cvt_pk_bf16_f32 v117, v134, v135
    s_waitcnt lgkmcnt(3)
    v_mfma_f32_32x32x16_bf16 v[0:15], a[16:19], v[156:159], v[32:47]
    ds_read_b128 a[4:7], v145 offset:33280
    v_exp_f32 v132, v28
    v_exp_f32 v133, v29
    v_mfma_f32_32x32x16_bf16 v[0:15], a[20:23], v[160:163], v[0:15]
    ds_read_b128 a[8:11], v144 offset:33536
    v_add_f32 v141, v141, v132
    v_add_f32 v141, v141, v133
    v_cvt_pk_bf16_f32 v118, v132, v133
    v_exp_f32 v134, v30
    s_waitcnt lgkmcnt(2)
    v_mfma_f32_32x32x16_bf16 v[0:15], a[24:27], v[164:167], v[0:15]
    ds_read_b128 a[12:15], v145 offset:33536
    v_exp_f32 v135, v31
    v_add_f32 v141, v141, v134
    v_add_f32 v141, v141, v135
    v_mfma_f32_32x32x16_bf16 v[0:15], a[28:31], v[168:171], v[0:15]
    v_cvt_pk_bf16_f32 v119, v134, v135
    v_cmp_nge_f32 vcc, 0x44800000, v141
    v_exp_f32 v154, v120
    v_mfma_f32_32x32x16_bf16 v[0:15], a[0:3], v[172:175], v[0:15]
    ds_read_b64_tr_b16 a[16:17], v146 offset:16384
    ds_read_b64_tr_b16 a[18:19], v146 offset:18432
    v_exp_f32 v155, v121
    s_nop 0
    v_add_f32 v143, v154, v155
    v_cvt_pk_bf16_f32 v128, v154, v155
    s_waitcnt lgkmcnt(2)
    v_mfma_f32_32x32x16_bf16 v[0:15], a[4:7], v[176:179], v[0:15]
    ds_read_b64_tr_b16 a[20:21], v146 offset:16640
    ds_read_b64_tr_b16 a[22:23], v146 offset:18688
    v_exp_f32 v154, v122
    v_exp_f32 v155, v123
    v_add_f32 v143, v143, v154
    v_mfma_f32_32x32x16_bf16 v[0:15], a[8:11], v[180:183], v[0:15]
    ds_read_b64_tr_b16 a[24:25], v146 offset:16896
    ds_read_b64_tr_b16 a[26:27], v146 offset:18944
    v_add_f32 v143, v143, v155
    v_cvt_pk_bf16_f32 v129, v154, v155
    v_exp_f32 v154, v124
    v_mfma_f32_32x32x16_bf16 v[0:15], a[12:15], v[184:187], v[0:15]
    ds_read_b64_tr_b16 a[28:29], v146 offset:17152
    ds_read_b64_tr_b16 a[30:31], v146 offset:19200
    v_exp_f32 v155, v125
    v_add_f32 v143, v143, v154
    v_add_f32 v143, v143, v155
    s_cbranch_vccnz L_rc_53
L_rb_54:
    v_add_f32 v140, v140, v141
    ds_read_b64_tr_b16 a[0:1], v146 offset:20480
    ds_read_b64_tr_b16 a[2:3], v146 offset:22528
    s_waitcnt lgkmcnt(4)
    v_mfma_f32_32x32x16_bf16 v[48:63], a[16:19], v[112:115], v[48:63]
    ds_read_b64_tr_b16 a[4:5], v146 offset:20736
    ds_read_b64_tr_b16 a[6:7], v146 offset:22784
    v_exp_f32 v132, v0
    v_exp_f32 v133, v1
    s_nop 0
    v_add_f32 v141, v132, v133
    v_mfma_f32_32x32x16_bf16 v[64:79], a[20:23], v[112:115], v[64:79]
    ds_read_b64_tr_b16 a[8:9], v146 offset:20992
    ds_read_b64_tr_b16 a[10:11], v146 offset:23040
    v_cvt_pk_bf16_f32 v130, v154, v155
    v_exp_f32 v154, v126
    v_exp_f32 v155, v127
    v_mfma_f32_32x32x16_bf16 v[80:95], a[24:27], v[112:115], v[80:95]
    ds_read_b64_tr_b16 a[12:13], v146 offset:21248
    ds_read_b64_tr_b16 a[14:15], v146 offset:23296
    v_add_f32 v143, v143, v154
    v_add_f32 v143, v143, v155
    v_cvt_pk_bf16_f32 v131, v154, v155
    s_waitcnt lgkmcnt(4)
    v_mfma_f32_32x32x16_bf16 v[96:111], a[28:31], v[112:115], v[96:111]
    v_cvt_pk_bf16_f32 v112, v132, v133
    v_exp_f32 v134, v2
    v_exp_f32 v135, v3
    v_mfma_f32_32x32x16_bf16 v[48:63], a[0:3], v[116:119], v[48:63]
    ds_read_b128 a[0:3], v144 offset:49152
    v_add_f32 v141, v141, v134
    v_add_f32 v141, v141, v135
    v_cvt_pk_bf16_f32 v113, v134, v135
    v_exp_f32 v132, v4
    v_mfma_f32_32x32x16_bf16 v[64:79], a[4:7], v[116:119], v[64:79]
    ds_read_b128 a[4:7], v145 offset:49152
    v_exp_f32 v133, v5
    v_add_f32 v141, v141, v132
    s_waitcnt lgkmcnt(2)
    v_mfma_f32_32x32x16_bf16 v[80:95], a[8:11], v[116:119], v[80:95]
    ds_read_b128 a[8:11], v144 offset:49408
    v_add_f32 v141, v141, v133
    v_cvt_pk_bf16_f32 v114, v132, v133
    v_exp_f32 v134, v6
    v_exp_f32 v135, v7
    v_add_f32 v141, v141, v134
    v_add_f32 v141, v141, v135
    v_cvt_pk_bf16_f32 v115, v134, v135
    v_mfma_f32_32x32x16_bf16 v[96:111], a[12:15], v[116:119], v[96:111]
    ds_read_b128 a[12:15], v145 offset:49408
    v_cmp_nge_f32 vcc, 0x44800000, v143
    s_cbranch_vccnz L_rc_55
L_rb_56:
    v_add_f32 v142, v142, v143
    s_barrier
    s_waitcnt lgkmcnt(1)
    v_mfma_f32_32x32x16_bf16 v[16:31], a[0:3], v[156:159], v[32:47]
    ds_read_b128 a[16:19], v144 offset:49664
    ds_read_b128 a[20:23], v145 offset:49664
    v_exp_f32 v132, v8
    v_mfma_f32_32x32x16_bf16 v[16:31], a[4:7], v[160:163], v[16:31]
    ds_read_b128 a[24:27], v144 offset:49920
    v_exp_f32 v133, v9
    v_add_f32 v141, v141, v132
    v_add_f32 v141, v141, v133
    v_mfma_f32_32x32x16_bf16 v[16:31], a[8:11], v[164:167], v[16:31]
    ds_read_b128 a[28:31], v145 offset:49920
    v_cvt_pk_bf16_f32 v116, v132, v133
    v_exp_f32 v134, v10
    s_waitcnt lgkmcnt(4)
    v_mfma_f32_32x32x16_bf16 v[16:31], a[12:15], v[168:171], v[16:31]
    v_exp_f32 v135, v11
    v_add_f32 v141, v141, v134
    s_waitcnt lgkmcnt(2)
    v_mfma_f32_32x32x16_bf16 v[16:31], a[16:19], v[172:175], v[16:31]
    ds_read_b64_tr_b16 a[0:1], v146 offset:32768
    ds_read_b64_tr_b16 a[2:3], v146 offset:34816
    v_add_f32 v141, v141, v135
    v_cvt_pk_bf16_f32 v117, v134, v135
    v_mfma_f32_32x32x16_bf16 v[16:31], a[20:23], v[176:179], v[16:31]
    ds_read_b64_tr_b16 a[4:5], v146 offset:33024
    ds_read_b64_tr_b16 a[6:7], v146 offset:35072
    v_exp_f32 v132, v12
    v_exp_f32 v133, v13
    s_waitcnt lgkmcnt(4)
    v_mfma_f32_32x32x16_bf16 v[16:31], a[24:27], v[180:183], v[16:31]
    ds_read_b64_tr_b16 a[8:9], v146 offset:33280
    ds_read_b64_tr_b16 a[10:11], v146 offset:35328
    v_add_f32 v141, v141, v132
    v_add_f32 v141, v141, v133
    v_mfma_f32_32x32x16_bf16 v[16:31], a[28:31], v[184:187], v[16:31]
    v_cvt_pk_bf16_f32 v118, v132, v133
    v_exp_f32 v134, v14
    v_exp_f32 v135, v15
    v_add_f32 v141, v141, v134
    v_add_f32 v141, v141, v135
    v_cvt_pk_bf16_f32 v119, v134, v135
    v_cmp_nge_f32 vcc, 0x44800000, v141
    ds_read_b64_tr_b16 a[12:13], v146 offset:33536
    ds_read_b64_tr_b16 a[14:15], v146 offset:35584
    s_cbranch_vccnz L_rc_57
L_rb_58:
    v_add_f32 v140, v140, v141
    ds_read_b64_tr_b16 a[16:17], v146 offset:36864
    ds_read_b64_tr_b16 a[18:19], v146 offset:38912
    s_waitcnt lgkmcnt(4)
    v_mfma_f32_32x32x16_bf16 v[48:63], a[0:3], v[112:115], v[48:63]
    ds_read_b64_tr_b16 a[20:21], v146 offset:37120
    ds_read_b64_tr_b16 a[22:23], v146 offset:39168
    v_mfma_f32_32x32x16_bf16 v[64:79], a[4:7], v[112:115], v[64:79]
    ds_read_b64_tr_b16 a[24:25], v146 offset:37376
    ds_read_b64_tr_b16 a[26:27], v146 offset:39424
    v_mfma_f32_32x32x16_bf16 v[80:95], a[8:11], v[112:115], v[80:95]
    ds_read_b64_tr_b16 a[28:29], v146 offset:37632
    ds_read_b64_tr_b16 a[30:31], v146 offset:39680
    v_exp_f32 v132, v16
    v_exp_f32 v133, v17
    s_waitcnt lgkmcnt(7)
    v_mfma_f32_32x32x16_bf16 v[96:111], a[12:15], v[112:115], v[96:111]
    ds_read_b64_tr_b16 a[0:1], v148 offset:32768
    ds_read_b64_tr_b16 a[2:3], v148 offset:36864
    v_add_f32 v141, v132, v133
    v_cvt_pk_bf16_f32 v112, v132, v133
    s_waitcnt lgkmcnt(6)
    v_mfma_f32_32x32x16_bf16 v[48:63], a[16:19], v[116:119], v[48:63]
    ds_read_b64_tr_b16 a[4:5], v149 offset:32768
    ds_read_b64_tr_b16 a[6:7], v149 offset:36864
    v_exp_f32 v134, v18
    v_mfma_f32_32x32x16_bf16 v[64:79], a[20:23], v[116:119], v[64:79]
    ds_read_b64_tr_b16 a[8:9], v148 offset:33024
    ds_read_b64_tr_b16 a[10:11], v148 offset:37120
    v_exp_f32 v135, v19
    v_add_f32 v141, v141, v134
    v_add_f32 v141, v141, v135
    s_waitcnt lgkmcnt(4)
    v_mfma_f32_32x32x16_bf16 v[80:95], a[24:27], v[116:119], v[80:95]
    ds_read_b64_tr_b16 a[12:13], v149 offset:33024
    ds_read_b64_tr_b16 a[14:15], v149 offset:37120
    v_cvt_pk_bf16_f32 v113, v134, v135
    v_exp_f32 v132, v20
    v_mfma_f32_32x32x16_bf16 v[96:111], a[28:31], v[116:119], v[96:111]
    ds_read_b64_tr_b16 a[16:17], v148 offset:33280
    ds_read_b64_tr_b16 a[18:19], v148 offset:37376
    v_exp_f32 v133, v21
    v_add_f32 v141, v141, v132
    v_mfma_f32_16x16x32_bf16 a[32:35], a[0:3], v[128:131], a[32:35]
    ds_read_b64_tr_b16 a[20:21], v149 offset:33280
    ds_read_b64_tr_b16 a[22:23], v149 offset:37376
    v_add_f32 v141, v141, v133
    s_waitcnt lgkmcnt(6)
    v_mfma_f32_16x16x32_bf16 a[36:39], a[4:7], v[128:131], a[36:39]
    ds_read_b64_tr_b16 a[24:25], v148 offset:33536
    ds_read_b64_tr_b16 a[26:27], v148 offset:37632
    v_cvt_pk_bf16_f32 v114, v132, v133
    v_mfma_f32_16x16x32_bf16 a[40:43], a[8:11], v[128:131], a[40:43]
    ds_read_b64_tr_b16 a[28:29], v149 offset:33536
    ds_read_b64_tr_b16 a[30:31], v149 offset:37632
    v_exp_f32 v134, v22
    s_waitcnt lgkmcnt(6)
    v_mfma_f32_16x16x32_bf16 a[44:47], a[12:15], v[128:131], a[44:47]
    v_mfma_f32_16x16x32_bf16 a[48:51], a[16:19], v[128:131], a[48:51]
    v_exp_f32 v135, v23
    s_waitcnt lgkmcnt(4)
    v_mfma_f32_16x16x32_bf16 a[52:55], a[20:23], v[128:131], a[52:55]
    v_add_f32 v141, v141, v134
    s_waitcnt lgkmcnt(2)
    v_mfma_f32_16x16x32_bf16 a[56:59], a[24:27], v[128:131], a[56:59]
    v_add_f32 v141, v141, v135
    v_cvt_pk_bf16_f32 v115, v134, v135
    s_waitcnt lgkmcnt(0)
    v_mfma_f32_16x16x32_bf16 a[60:63], a[28:31], v[128:131], a[60:63]
    s_barrier
    v_and_b32 v150, 0x3ff, v150
    s_lshl_b32 s46, s58, 14
    s_add_u32 s46, s46, 0x10000
    v_add_u32 v144, s46, v150
    v_lshrrev_b32 v187, 1, v150
    s_lshl_b32 s46, s58, 9
    s_add_u32 s46, s46, 0x21000
    v_add_u32 v145, s46, v187
    s_lshl_b32 s46, s58, 13
    s_add_u32 s46, s46, 0x0
    v_add_u32 v147, s46, v150
    ds_read_b64_tr_b16 a[0:1], v146 offset:49152
    ds_read_b64_tr_b16 a[2:3], v146 offset:51200
    ds_read_b64_tr_b16 a[4:5], v146 offset:53248
    ds_read_b64_tr_b16 a[6:7], v146 offset:55296
    ds_read_b64_tr_b16 a[8:9], v146 offset:49408
    ds_read_b64_tr_b16 a[10:11], v146 offset:51456
    ds_read_b64_tr_b16 a[12:13], v146 offset:53504
    ds_read_b64_tr_b16 a[14:15], v146 offset:55552
    ds_read_b64_tr_b16 a[16:17], v146 offset:49664
    ds_read_b64_tr_b16 a[18:19], v146 offset:51712
    ds_read_b64_tr_b16 a[20:21], v146 offset:53760
    ds_read_b64_tr_b16 a[22:23], v146 offset:55808
    ds_read_b64_tr_b16 a[24:25], v146 offset:49920
    ds_read_b64_tr_b16 a[26:27], v146 offset:51968
    v_exp_f32 v132, v24
    v_exp_f32 v133, v25
    v_add_f32 v141, v141, v132
    v_add_f32 v141, v141, v133
    v_cvt_pk_bf16_f32 v116, v132, v133
    v_exp_f32 v134, v26
    v_exp_f32 v135, v27
    v_add_f32 v141, v141, v134
    v_add_f32 v141, v141, v135
    v_cvt_pk_bf16_f32 v117, v134, v135
    v_exp_f32 v132, v28
    v_exp_f32 v133, v29
    v_add_f32 v141, v141, v132
    v_add_f32 v141, v141, v133
    v_cvt_pk_bf16_f32 v118, v132, v133
    v_exp_f32 v134, v30
    v_exp_f32 v135, v31
    v_add_f32 v141, v141, v134
    v_add_f32 v141, v141, v135
    v_cvt_pk_bf16_f32 v119, v134, v135
    v_cmp_nge_f32 vcc, 0x44800000, v141
    s_cbranch_vccnz L_rc_59
L_rb_60:
    v_add_f32 v140, v140, v141
    s_waitcnt lgkmcnt(0)
    v_mfma_f32_32x32x16_bf16 v[48:63], a[0:3], v[112:115], v[48:63]
    ds_read_b64_tr_b16 a[28:29], v146 offset:54016
    ds_read_b64_tr_b16 a[30:31], v146 offset:56064
    v_mov_b32 v154, v32
    v_mov_b32 v155, v140
    ds_write_b64 v145, v[154:155] offset:2048
    v_mov_b32 v152, v136
    v_mov_b32 v153, v142
    ds_write_b64 v145, v[152:153] offset:4096
    ds_write_b128 v147, a[32:35] offset:0
    ds_write_b128 v147, a[36:39] offset:1024
    ds_write_b128 v147, a[40:43] offset:2048
    ds_write_b128 v147, a[44:47] offset:3072
    ds_write_b128 v147, a[48:51] offset:4096
    ds_write_b128 v147, a[52:55] offset:5120
    ds_write_b128 v147, a[56:59] offset:6144
    ds_write_b128 v147, a[60:63] offset:7168
    v_mfma_f32_32x32x16_bf16 v[48:63], a[4:7], v[116:119], v[48:63]
    v_mfma_f32_32x32x16_bf16 v[64:79], a[8:11], v[112:115], v[64:79]
    s_nop 10
    ds_write_b128 v144, v[48:51] offset:0
    ds_write_b128 v144, v[52:55] offset:1024
    v_mfma_f32_32x32x16_bf16 v[64:79], a[12:15], v[116:119], v[64:79]
    v_mfma_f32_32x32x16_bf16 v[80:95], a[16:19], v[112:115], v[80:95]
    v_mfma_f32_32x32x16_bf16 v[80:95], a[20:23], v[116:119], v[80:95]
    v_mfma_f32_32x32x16_bf16 v[96:111], a[24:27], v[112:115], v[96:111]
    ds_write_b128 v144, v[56:59] offset:2048
    s_waitcnt lgkmcnt(14)
    ds_write_b128 v144, v[60:63] offset:3072
    s_waitcnt lgkmcnt(14)
    s_nop 4
    ds_write_b128 v144, v[64:67] offset:4096
    s_waitcnt lgkmcnt(14)
    ds_write_b128 v144, v[68:71] offset:5120
    s_waitcnt lgkmcnt(14)
    ds_write_b128 v144, v[72:75] offset:6144
    s_waitcnt lgkmcnt(14)
    ds_write_b128 v144, v[76:79] offset:7168
    v_mfma_f32_32x32x16_bf16 v[96:111], a[28:31], v[116:119], v[96:111]
    s_waitcnt lgkmcnt(0)
    s_barrier
    ds_read_b64 v[132:133], v145 offset:0
    ds_read_b128 v[0:3], v144 offset:8192
    ds_read_b128 v[4:7], v144 offset:9216
    ds_read_b128 v[8:11], v144 offset:10240
    ds_read_b128 v[12:15], v144 offset:11264
    ds_read_b128 v[16:19], v144 offset:12288
    ds_read_b128 v[20:23], v144 offset:13312
    ds_read_b128 v[24:27], v144 offset:14336
    ds_read_b128 v[28:31], v144 offset:15360
    v_add_u32 v155, 0x22000, v187
    s_lshl_b32 s46, s58, 11
    s_add_u32 s46, s46, 0x400
    v_add_u32 v154, s46, v150
    s_lshl_b32 s46, s20, 12
    s_add_u32 s46, s46, 0x8000
    v_lshrrev_b32 v149, 4, v150
    v_and_b32 v152, 31, v149
    v_and_b32 v148, 7, v149
    v_lshlrev_b32 v152, 7, v152
    v_lshl_or_b32 v152, v148, 4, v152
    v_lshrrev_b32 v153, 5, v149
    v_lshl_or_b32 v152, v153, 3, v152
    v_add_u32 v152, s46, v152
    v_lshrrev_b32 v149, 3, v149
    v_xor_b32 v153, v149, v148
    v_and_b32 v153, 7, v153
    v_lshlrev_b32 v153, 4, v153
    v_lshl_or_b32 v153, v149, 7, v153
    v_add_u32 v153, s46, v153
    s_lshl_b32 s46, s58, 5
    v_add_u32 v149, s46, v149
    v_lshlrev_b32 v149, 8, v149
    v_lshl_or_b32 v148, v148, 4, v149
    v_lshrrev_b32 v149, 4, v150
    v_and_b32 v146, 15, v149
    v_lshrrev_b32 v149, 4, v149
    v_add_u32 v146, 128, v146
    v_lshlrev_b32 v146, 8, v146
    v_lshl_or_b32 v146, v149, 3, v146
    s_lshl_b32 s46, s58, 6
    v_add_u32 v146, s46, v146
    ds_read_b64 v[156:157], v155 offset:0
    ds_read_b64 v[158:159], v155 offset:512
    ds_read_b64 v[160:161], v155 offset:1024
    ds_read_b64 v[162:163], v155 offset:1536
    s_waitcnt lgkmcnt(4)
    v_min_f32 v120, v32, v132
    v_sub_f32 v122, v120, v32
    v_sub_f32 v124, v120, v132
    v_exp_f32 v122, v122
    v_exp_f32 v124, v124
    v_mul_f32 v121, v122, v140
    v_fmac_f32 v121, v124, v133
    v_mov_b32 v123, v121
    s_nop 1
    v_permlane32_swap_b32 v121, v123
    v_add_f32 v121, v121, v123
    v_rcp_f32 v121, v121
    s_nop 0
    v_mul_f32 v122, v122, v121
    v_mul_f32 v124, v124, v121
    v_pk_mul_f32 v[80:81], v[80:81], v[122:123] op_sel_hi:[1,0]
    v_pk_mul_f32 v[82:83], v[82:83], v[122:123] op_sel_hi:[1,0]
    v_pk_mul_f32 v[84:85], v[84:85], v[122:123] op_sel_hi:[1,0]
    v_pk_mul_f32 v[86:87], v[86:87], v[122:123] op_sel_hi:[1,0]
    v_pk_mul_f32 v[88:89], v[88:89], v[122:123] op_sel_hi:[1,0]
    v_pk_mul_f32 v[90:91], v[90:91], v[122:123] op_sel_hi:[1,0]
    v_pk_mul_f32 v[92:93], v[92:93], v[122:123] op_sel_hi:[1,0]
    v_pk_mul_f32 v[94:95], v[94:95], v[122:123] op_sel_hi:[1,0]
    v_pk_fma_f32 v[80:81], v[0:1], v[124:125], v[80:81] op_sel_hi:[1,0,1]
    v_pk_fma_f32 v[82:83], v[2:3], v[124:125], v[82:83] op_sel_hi:[1,0,1]
    v_pk_fma_f32 v[84:85], v[4:5], v[124:125], v[84:85] op_sel_hi:[1,0,1]
    v_pk_fma_f32 v[86:87], v[6:7], v[124:125], v[86:87] op_sel_hi:[1,0,1]
    v_pk_fma_f32 v[88:89], v[8:9], v[124:125], v[88:89] op_sel_hi:[1,0,1]
    v_pk_fma_f32 v[90:91], v[10:11], v[124:125], v[90:91] op_sel_hi:[1,0,1]
    v_pk_fma_f32 v[92:93], v[12:13], v[124:125], v[92:93] op_sel_hi:[1,0,1]
    v_pk_fma_f32 v[94:95], v[14:15], v[124:125], v[94:95] op_sel_hi:[1,0,1]
    ds_read_b128 v[164:167], v154 offset:0
    ds_read_b128 v[168:171], v154 offset:8192
    ds_read_b128 v[172:175], v154 offset:16384
    ds_read_b128 v[176:179], v154 offset:24576
    v_cvt_pk_bf16_f32 v32, v80, v81
    v_cvt_pk_bf16_f32 v33, v82, v83
    v_cvt_pk_bf16_f32 v34, v84, v85
    v_cvt_pk_bf16_f32 v35, v86, v87
    v_cvt_pk_bf16_f32 v36, v88, v89
    v_cvt_pk_bf16_f32 v37, v90, v91
    v_cvt_pk_bf16_f32 v38, v92, v93
    v_cvt_pk_bf16_f32 v39, v94, v95
    v_xor_b32 v125, 0, v152
    ds_write_b64 v125, v[32:33]
    v_xor_b32 v126, 16, v152
    ds_write_b64 v126, v[34:35]
    v_xor_b32 v125, 32, v152
    ds_write_b64 v125, v[36:37]
    v_xor_b32 v126, 48, v152
    ds_write_b64 v126, v[38:39]
    v_pk_mul_f32 v[96:97], v[96:97], v[122:123] op_sel_hi:[1,0]
    v_pk_mul_f32 v[98:99], v[98:99], v[122:123] op_sel_hi:[1,0]
    v_pk_mul_f32 v[100:101], v[100:101], v[122:123] op_sel_hi:[1,0]
    v_pk_mul_f32 v[102:103], v[102:103], v[122:123] op_sel_hi:[1,0]
    v_pk_mul_f32 v[104:105], v[104:105], v[122:123] op_sel_hi:[1,0]
    v_pk_mul_f32 v[106:107], v[106:107], v[122:123] op_sel_hi:[1,0]
    v_pk_mul_f32 v[108:109], v[108:109], v[122:123] op_sel_hi:[1,0]
    v_pk_mul_f32 v[110:111], v[110:111], v[122:123] op_sel_hi:[1,0]
    v_pk_fma_f32 v[96:97], v[16:17], v[124:125], v[96:97] op_sel_hi:[1,0,1]
    v_pk_fma_f32 v[98:99], v[18:19], v[124:125], v[98:99] op_sel_hi:[1,0,1]
    v_pk_fma_f32 v[100:101], v[20:21], v[124:125], v[100:101] op_sel_hi:[1,0,1]
    v_pk_fma_f32 v[102:103], v[22:23], v[124:125], v[102:103] op_sel_hi:[1,0,1]
    v_pk_fma_f32 v[104:105], v[24:25], v[124:125], v[104:105] op_sel_hi:[1,0,1]
    v_pk_fma_f32 v[106:107], v[26:27], v[124:125], v[106:107] op_sel_hi:[1,0,1]
    v_pk_fma_f32 v[108:109], v[28:29], v[124:125], v[108:109] op_sel_hi:[1,0,1]
    v_pk_fma_f32 v[110:111], v[30:31], v[124:125], v[110:111] op_sel_hi:[1,0,1]
    v_cvt_pk_bf16_f32 v40, v96, v97
    v_cvt_pk_bf16_f32 v41, v98, v99
    v_cvt_pk_bf16_f32 v42, v100, v101
    v_cvt_pk_bf16_f32 v43, v102, v103
    v_cvt_pk_bf16_f32 v44, v104, v105
    v_cvt_pk_bf16_f32 v45, v106, v107
    v_cvt_pk_bf16_f32 v46, v108, v109
    v_cvt_pk_bf16_f32 v47, v110, v111
    v_xor_b32 v125, 64, v152
    ds_write_b64 v125, v[40:41]
    v_xor_b32 v126, 80, v152
    ds_write_b64 v126, v[42:43]
    v_xor_b32 v125, 96, v152
    ds_write_b64 v125, v[44:45]
    v_xor_b32 v126, 112, v152
    s_waitcnt lgkmcnt(12)
    ds_write_b64 v126, v[46:47]
    ds_read_b128 v[48:51], v153 offset:0
    ds_read_b128 v[52:55], v153 offset:1024
    s_waitcnt lgkmcnt(12)
    ds_read_b128 v[56:59], v153 offset:2048
    ds_read_b128 v[60:63], v153 offset:3072
    s_mov_b32 s46, 0
    s_waitcnt lgkmcnt(3)
    buffer_store_dwordx4 v[48:51], v148, s[16:19], s46 offen offset:128 nt
    s_mov_b32 s46, 2048
    s_waitcnt lgkmcnt(2)
    buffer_store_dwordx4 v[52:55], v148, s[16:19], s46 offen offset:128 nt
    s_mov_b32 s46, 4096
    s_waitcnt lgkmcnt(1)
    buffer_store_dwordx4 v[56:59], v148, s[16:19], s46 offen offset:128 nt
    s_mov_b32 s46, 6144
    s_waitcnt lgkmcnt(0)
    buffer_store_dwordx4 v[60:63], v148, s[16:19], s46 offen offset:128 nt
    v_min_f32 v120, v156, v158
    v_min3_f32 v120, v120, v160, v162
    v_sub_f32 v128, v120, v156
    v_sub_f32 v129, v120, v158
    v_sub_f32 v130, v120, v160
    v_sub_f32 v131, v120, v162
    v_exp_f32 v128, v128
    v_exp_f32 v129, v129
    v_exp_f32 v130, v130
    v_exp_f32 v131, v131
    v_mul_f32 v121, v128, v157
    v_fmac_f32 v121, v129, v159
    v_fmac_f32 v121, v130, v161
    v_fmac_f32 v121, v131, v163
    v_mov_b32 v123, v121
    s_nop 1
    v_permlane32_swap_b32 v121, v123
    v_add_f32 v121, v121, v123
    v_mov_b32 v123, v121
    s_nop 1
    v_permlane16_swap_b32 v121, v123
    v_add_f32 v121, v121, v123
    v_rcp_f32 v121, v121
    s_nop 0
    v_mul_f32 v128, v128, v121
    v_mul_f32 v129, v129, v121
    v_mul_f32 v130, v130, v121
    v_mul_f32 v131, v131, v121
    v_mul_f32 v164, v164, v128
    v_mul_f32 v165, v165, v128
    v_mul_f32 v166, v166, v128
    v_mul_f32 v167, v167, v128
    v_fmac_f32 v164, v168, v129
    v_fmac_f32 v165, v169, v129
    v_fmac_f32 v166, v170, v129
    v_fmac_f32 v167, v171, v129
    v_fmac_f32 v164, v172, v130
    v_fmac_f32 v165, v173, v130
    v_fmac_f32 v166, v174, v130
    v_fmac_f32 v167, v175, v130
    v_fmac_f32 v164, v176, v131
    v_fmac_f32 v165, v177, v131
    v_fmac_f32 v166, v178, v131
    v_fmac_f32 v167, v179, v131
    v_cvt_pk_bf16_f32 v132, v164, v165
    v_cvt_pk_bf16_f32 v133, v166, v167
    buffer_store_dwordx2 v[132:133], v146, s[16:19], 0 offen offset:32 nt
    s_endpgm
    s_nop 0
L_role2:
    v_lshlrev_b32 v8, 10, v4
    v_lshl_or_b32 v8, v5, 6, v8
    v_xor_b32 v9, v6, v4
    v_lshl_or_b32 v8, v9, 4, v8
    s_and_b32 s47, s20, 1
    s_lshl_b32 s47, s47, 13
    s_add_u32 s46, s47, 0x10000
    v_add_u32 v147, s46, v8
    v_lshlrev_b32 v8, 10, v6
    v_lshl_or_b32 v8, v4, 6, v8
    v_and_b32 v9, 1, v6
    v_lshl_or_b32 v8, v9, 5, v8
    v_lshl_or_b32 v8, v5, 3, v8
    v_add_u32 v148, s47, v8
    v_xor_b32 v149, 32, v148
    v_add_u32 v150, 0x20000, v150
    v_accvgpr_write_b32 a32, 0
    v_accvgpr_write_b32 a33, 0
    v_accvgpr_write_b32 a34, 0
    v_accvgpr_write_b32 a35, 0
    v_accvgpr_write_b32 a36, 0
    v_accvgpr_write_b32 a37, 0
    v_accvgpr_write_b32 a38, 0
    v_accvgpr_write_b32 a39, 0
    v_accvgpr_write_b32 a40, 0
    v_accvgpr_write_b32 a41, 0
    v_accvgpr_write_b32 a42, 0
    v_accvgpr_write_b32 a43, 0
    v_accvgpr_write_b32 a44, 0
    v_accvgpr_write_b32 a45, 0
    v_accvgpr_write_b32 a46, 0
    v_accvgpr_write_b32 a47, 0
    v_accvgpr_write_b32 a48, 0
    v_accvgpr_write_b32 a49, 0
    v_accvgpr_write_b32 a50, 0
    v_accvgpr_write_b32 a51, 0
    v_accvgpr_write_b32 a52, 0
    v_accvgpr_write_b32 a53, 0
    v_accvgpr_write_b32 a54, 0
    v_accvgpr_write_b32 a55, 0
    v_accvgpr_write_b32 a56, 0
    v_accvgpr_write_b32 a57, 0
    v_accvgpr_write_b32 a58, 0
    v_accvgpr_write_b32 a59, 0
    v_accvgpr_write_b32 a60, 0
    v_accvgpr_write_b32 a61, 0
    v_accvgpr_write_b32 a62, 0
    v_accvgpr_write_b32 a63, 0
    s_waitcnt vmcnt(12)
    v_lshlrev_b32 v16, 16, v112
    v_and_b32 v17, 0xffff0000, v112
    v_mul_f32 v16, s22, v16
    v_mul_f32 v17, s22, v17
    v_cvt_pk_bf16_f32 v112, v16, v17
    v_lshlrev_b32 v18, 16, v113
    v_and_b32 v19, 0xffff0000, v113
    v_mul_f32 v18, s22, v18
    v_mul_f32 v19, s22, v19
    v_cvt_pk_bf16_f32 v113, v18, v19
    v_lshlrev_b32 v20, 16, v114
    v_and_b32 v21, 0xffff0000, v114
    v_mul_f32 v20, s22, v20
    v_mul_f32 v21, s22, v21
    v_cvt_pk_bf16_f32 v114, v20, v21
    v_lshlrev_b32 v22, 16, v115
    v_and_b32 v23, 0xffff0000, v115
    v_mul_f32 v22, s22, v22
    v_mul_f32 v23, s22, v23
    v_cvt_pk_bf16_f32 v115, v22, v23
    s_lshl_b32 s46, s58, 10
    v_add_u32 v8, s46, v150
    ds_write_b128 v8, v[112:115]
    s_setprio 1
    s_waitcnt vmcnt(6) lgkmcnt(0)
    s_barrier
    ds_read_b128 v[156:159], v132 offset:0
    ds_read_b128 v[160:163], v133 offset:0
    ds_read_b128 v[164:167], v132 offset:256
    ds_read_b128 a[0:3], v144 offset:0
    s_waitcnt lgkmcnt(3)
    v_lshlrev_b32 v16, 16, v156
    v_and_b32 v17, 0xffff0000, v156
    v_lshlrev_b32 v18, 16, v157
    v_and_b32 v19, 0xffff0000, v157
    v_lshlrev_b32 v20, 16, v158
    v_and_b32 v21, 0xffff0000, v158
    v_lshlrev_b32 v22, 16, v159
    v_and_b32 v23, 0xffff0000, v159
    v_mul_f32 v16, s22, v16
    v_mul_f32 v17, s22, v17
    v_mul_f32 v18, s22, v18
    v_mul_f32 v19, s22, v19
    v_mul_f32 v20, s22, v20
    v_mul_f32 v21, s22, v21
    v_mul_f32 v22, s22, v22
    v_mul_f32 v23, s22, v23
    v_cvt_pk_bf16_f32 v156, v16, v17
    v_cvt_pk_bf16_f32 v157, v18, v19
    v_cvt_pk_bf16_f32 v158, v20, v21
    v_cvt_pk_bf16_f32 v159, v22, v23
    s_waitcnt lgkmcnt(0)
    s_nop 0
    v_mfma_f32_32x32x16_bf16 v[0:15], a[0:3], v[156:159], 0
    ds_read_b128 v[168:171], v133 offset:256
    ds_read_b128 a[4:7], v145 offset:0
    v_lshlrev_b32 v24, 16, v160
    v_and_b32 v25, 0xffff0000, v160
    v_lshlrev_b32 v26, 16, v161
    v_and_b32 v27, 0xffff0000, v161
    v_lshlrev_b32 v28, 16, v162
    v_and_b32 v29, 0xffff0000, v162
    v_lshlrev_b32 v30, 16, v163
    v_and_b32 v31, 0xffff0000, v163
    v_mul_f32 v24, s22, v24
    v_mul_f32 v25, s22, v25
    v_mul_f32 v26, s22, v26
    v_mul_f32 v27, s22, v27
    v_mul_f32 v28, s22, v28
    v_mul_f32 v29, s22, v29
    v_mul_f32 v30, s22, v30
    v_mul_f32 v31, s22, v31
    v_cvt_pk_bf16_f32 v160, v24, v25
    v_cvt_pk_bf16_f32 v161, v26, v27
    v_cvt_pk_bf16_f32 v162, v28, v29
    v_cvt_pk_bf16_f32 v163, v30, v31
    ds_read_b128 v[172:175], v132 offset:512
    s_waitcnt lgkmcnt(1)
    v_mfma_f32_32x32x16_bf16 v[0:15], a[4:7], v[160:163], v[0:15]
    ds_read_b128 a[8:11], v144 offset:256
    v_lshlrev_b32 v16, 16, v164
    v_and_b32 v17, 0xffff0000, v164
    v_lshlrev_b32 v18, 16, v165
    v_and_b32 v19, 0xffff0000, v165
    v_lshlrev_b32 v20, 16, v166
    v_and_b32 v21, 0xffff0000, v166
    v_lshlrev_b32 v22, 16, v167
    v_and_b32 v23, 0xffff0000, v167
    v_mul_f32 v16, s22, v16
    v_mul_f32 v17, s22, v17
    v_mul_f32 v18, s22, v18
    v_mul_f32 v19, s22, v19
    v_mul_f32 v20, s22, v20
    v_mul_f32 v21, s22, v21
    v_mul_f32 v22, s22, v22
    v_mul_f32 v23, s22, v23
    v_cvt_pk_bf16_f32 v164, v16, v17
    v_cvt_pk_bf16_f32 v165, v18, v19
    v_cvt_pk_bf16_f32 v166, v20, v21
    v_cvt_pk_bf16_f32 v167, v22, v23
    ds_read_b128 v[176:179], v133 offset:512
    ds_read_b128 v[180:183], v132 offset:768
    s_add_u32 s27, s26, 0x4000
    s_and_b32 s27, s27, 0x3ffff
    s_add_u32 s27, s27, s43
    s_add_u32 m0, s42, 0x4000
    s_add_u32 s44, s27, 0x0
    buffer_load_dwordx4 v152, s[8:11], s44 offen nt lds
    s_waitcnt lgkmcnt(2)
    v_mfma_f32_32x32x16_bf16 v[0:15], a[8:11], v[164:167], v[0:15]
    ds_read_b128 a[12:15], v145 offset:256
    v_lshlrev_b32 v24, 16, v168
    v_and_b32 v25, 0xffff0000, v168
    v_lshlrev_b32 v26, 16, v169
    v_and_b32 v27, 0xffff0000, v169
    v_lshlrev_b32 v28, 16, v170
    v_and_b32 v29, 0xffff0000, v170
    v_lshlrev_b32 v30, 16, v171
    v_and_b32 v31, 0xffff0000, v171
    v_mul_f32 v24, s22, v24
    v_mul_f32 v25, s22, v25
    v_mul_f32 v26, s22, v26
    v_mul_f32 v27, s22, v27
    v_mul_f32 v28, s22, v28
    v_mul_f32 v29, s22, v29
    v_mul_f32 v30, s22, v30
    v_mul_f32 v31, s22, v31
    v_cvt_pk_bf16_f32 v168, v24, v25
    v_cvt_pk_bf16_f32 v169, v26, v27
    v_cvt_pk_bf16_f32 v170, v28, v29
    v_cvt_pk_bf16_f32 v171, v30, v31
    ds_read_b128 v[184:187], v133 offset:768
    ds_read_b128 a[16:19], v144 offset:512
    s_waitcnt lgkmcnt(2)
    v_mfma_f32_32x32x16_bf16 v[0:15], a[12:15], v[168:171], v[0:15]
    v_lshlrev_b32 v16, 16, v172
    v_and_b32 v17, 0xffff0000, v172
    v_lshlrev_b32 v18, 16, v173
    v_and_b32 v19, 0xffff0000, v173
    v_lshlrev_b32 v20, 16, v174
    v_and_b32 v21, 0xffff0000, v174
    v_lshlrev_b32 v22, 16, v175
    v_and_b32 v23, 0xffff0000, v175
    v_mul_f32 v16, s22, v16
    v_mul_f32 v17, s22, v17
    v_mul_f32 v18, s22, v18
    v_mul_f32 v19, s22, v19
    v_mul_f32 v20, s22, v20
    v_mul_f32 v21, s22, v21
    v_mul_f32 v22, s22, v22
    v_mul_f32 v23, s22, v23
    v_cvt_pk_bf16_f32 v172, v16, v17
    v_cvt_pk_bf16_f32 v173, v18, v19
    v_cvt_pk_bf16_f32 v174, v20, v21
    v_cvt_pk_bf16_f32 v175, v22, v23
    ds_read_b128 a[20:23], v145 offset:512
    ds_read_b128 a[24:27], v144 offset:768
    ds_read_b128 a[28:31], v145 offset:768
    v_lshlrev_b32 v24, 16, v176
    v_and_b32 v25, 0xffff0000, v176
    v_lshlrev_b32 v26, 16, v177
    v_and_b32 v27, 0xffff0000, v177
    v_lshlrev_b32 v28, 16, v178
    v_and_b32 v29, 0xffff0000, v178
    v_lshlrev_b32 v30, 16, v179
    v_and_b32 v31, 0xffff0000, v179
    v_mul_f32 v24, s22, v24
    v_mul_f32 v25, s22, v25
    v_mul_f32 v26, s22, v26
    v_mul_f32 v27, s22, v27
    v_mul_f32 v28, s22, v28
    v_mul_f32 v29, s22, v29
    v_mul_f32 v30, s22, v30
    v_mul_f32 v31, s22, v31
    v_cvt_pk_bf16_f32 v176, v24, v25
    v_cvt_pk_bf16_f32 v177, v26, v27
    v_cvt_pk_bf16_f32 v178, v28, v29
    v_cvt_pk_bf16_f32 v179, v30, v31
    s_add_u32 m0, s42, 0x5000
    s_add_u32 s44, s27, 0x1000
    buffer_load_dwordx4 v152, s[8:11], s44 offen nt lds
    s_waitcnt lgkmcnt(0)
    v_mfma_f32_32x32x16_bf16 v[0:15], a[16:19], v[172:175], v[0:15]
    v_lshlrev_b32 v16, 16, v180
    v_and_b32 v17, 0xffff0000, v180
    v_lshlrev_b32 v18, 16, v181
    v_and_b32 v19, 0xffff0000, v181
    v_lshlrev_b32 v20, 16, v182
    v_and_b32 v21, 0xffff0000, v182
    v_lshlrev_b32 v22, 16, v183
    v_and_b32 v23, 0xffff0000, v183
    v_mul_f32 v16, s22, v16
    v_mul_f32 v17, s22, v17
    v_mul_f32 v18, s22, v18
    v_mul_f32 v19, s22, v19
    v_mul_f32 v20, s22, v20
    v_mul_f32 v21, s22, v21
    v_mul_f32 v22, s22, v22
    v_mul_f32 v23, s22, v23
    v_cvt_pk_bf16_f32 v180, v16, v17
    v_cvt_pk_bf16_f32 v181, v18, v19
    v_cvt_pk_bf16_f32 v182, v20, v21
    v_cvt_pk_bf16_f32 v183, v22, v23
    v_mfma_f32_32x32x16_bf16 v[0:15], a[20:23], v[176:179], v[0:15]
    s_add_u32 s27, s26, 0xc000
    s_and_b32 s27, s27, 0x3ffff
    s_add_u32 s27, s27, s43
    s_add_u32 m0, s42, 0x1c000
    s_add_u32 s44, s27, 0x0
    buffer_load_dwordx4 v151, s[4:7], s44 offen nt lds
    s_add_u32 m0, s42, 0x1d000
    s_add_u32 s44, s27, 0x1000
    buffer_load_dwordx4 v151, s[4:7], s44 offen nt lds
    v_lshlrev_b32 v24, 16, v184
    v_and_b32 v25, 0xffff0000, v184
    v_lshlrev_b32 v26, 16, v185
    v_and_b32 v27, 0xffff0000, v185
    v_lshlrev_b32 v28, 16, v186
    v_and_b32 v29, 0xffff0000, v186
    v_lshlrev_b32 v30, 16, v187
    v_and_b32 v31, 0xffff0000, v187
    v_mul_f32 v24, s22, v24
    v_mul_f32 v25, s22, v25
    v_mul_f32 v26, s22, v26
    v_mul_f32 v27, s22, v27
    v_mul_f32 v28, s22, v28
    v_mul_f32 v29, s22, v29
    v_mul_f32 v30, s22, v30
    v_mul_f32 v31, s22, v31
    v_cvt_pk_bf16_f32 v184, v24, v25
    v_cvt_pk_bf16_f32 v185, v26, v27
    v_cvt_pk_bf16_f32 v186, v28, v29
    v_cvt_pk_bf16_f32 v187, v30, v31
    v_mfma_f32_32x32x16_bf16 v[0:15], a[24:27], v[180:183], v[0:15]
    s_nop 0
    v_mfma_f32_32x32x16_bf16 v[0:15], a[28:31], v[184:187], v[0:15]
    s_nop 11
    v_max3_f32 v134, v0, v1, v2
    v_max3_f32 v134, v134, v3, v4
    v_max3_f32 v134, v134, v5, v6
    v_max3_f32 v134, v134, v7, v8
    v_max3_f32 v134, v134, v9, v10
    v_max3_f32 v134, v134, v11, v12
    v_max3_f32 v134, v134, v13, v14
    v_max_f32 v134, v134, v15
    v_mov_b32 v135, v134
    s_nop 1
    v_permlane32_swap_b32 v134, v135
    v_max_f32 v134, v134, v135
    v_sub_f32 v0, v0, v134
    v_sub_f32 v1, v1, v134
    v_sub_f32 v2, v2, v134
    v_sub_f32 v3, v3, v134
    v_sub_f32 v4, v4, v134
    v_sub_f32 v5, v5, v134
    v_sub_f32 v6, v6, v134
    v_sub_f32 v7, v7, v134
    v_sub_f32 v8, v8, v134
    v_sub_f32 v9, v9, v134
    v_sub_f32 v10, v10, v134
    v_sub_f32 v11, v11, v134
    v_sub_f32 v12, v12, v134
    v_sub_f32 v13, v13, v134
    v_sub_f32 v14, v14, v134
    v_sub_f32 v15, v15, v134
    v_sub_f32 v32, 0, v134
    v_sub_f32 v33, 0, v134
    v_sub_f32 v34, 0, v134
    v_sub_f32 v35, 0, v134
    v_sub_f32 v36, 0, v134
    v_sub_f32 v37, 0, v134
    v_sub_f32 v38, 0, v134
    v_sub_f32 v39, 0, v134
    v_sub_f32 v40, 0, v134
    v_sub_f32 v41, 0, v134
    v_sub_f32 v42, 0, v134
    v_sub_f32 v43, 0, v134
    v_sub_f32 v44, 0, v134
    v_sub_f32 v45, 0, v134
    v_sub_f32 v46, 0, v134
    v_sub_f32 v47, 0, v134
    v_exp_f32 v132, v0
    v_exp_f32 v133, v1
    s_nop 0
    v_add_f32 v141, v132, v133
    v_cvt_pk_bf16_f32 v112, v132, v133
    v_exp_f32 v134, v2
    v_exp_f32 v135, v3
    v_add_f32 v141, v141, v134
    v_add_f32 v141, v141, v135
    v_cvt_pk_bf16_f32 v113, v134, v135
    v_exp_f32 v132, v4
    v_exp_f32 v133, v5
    v_add_f32 v141, v141, v132
    v_add_f32 v141, v141, v133
    v_cvt_pk_bf16_f32 v114, v132, v133
    v_exp_f32 v134, v6
    v_exp_f32 v135, v7
    v_add_f32 v141, v141, v134
    v_add_f32 v141, v141, v135
    v_cvt_pk_bf16_f32 v115, v134, v135
    s_waitcnt vmcnt(4)
    s_barrier
    ds_read_b128 a[0:3], v147 offset:16384
    ds_read_b128 a[4:7], v150 offset:0
    s_waitcnt lgkmcnt(0)
    v_mfma_f32_16x16x32_bf16 v[120:123], a[0:3], a[4:7], 0
    ds_read_b128 a[8:11], v147 offset:20480
    ds_read_b128 a[12:15], v147 offset:16640
    ds_read_b128 a[16:19], v150 offset:1024
    v_exp_f32 v132, v8
    s_waitcnt lgkmcnt(2)
    v_mfma_f32_16x16x32_bf16 v[124:127], a[8:11], a[4:7], 0
    ds_read_b128 a[20:23], v147 offset:20736
    ds_read_b128 a[24:27], v147 offset:16896
    ds_read_b128 a[28:31], v150 offset:2048
    v_exp_f32 v133, v9
    s_waitcnt lgkmcnt(3)
    v_mfma_f32_16x16x32_bf16 v[120:123], a[12:15], a[16:19], v[120:123]
    ds_read_b128 a[0:3], v147 offset:20992
    ds_read_b128 a[4:7], v147 offset:17152
    ds_read_b128 a[8:11], v150 offset:3072
    v_add_f32 v141, v141, v132
    v_add_f32 v141, v141, v133
    v_cvt_pk_bf16_f32 v116, v132, v133
    s_waitcnt lgkmcnt(5)
    v_mfma_f32_16x16x32_bf16 v[124:127], a[20:23], a[16:19], v[124:127]
    ds_read_b128 a[12:15], v147 offset:21248
    ds_read_b128 a[16:19], v144 offset:16384
    v_exp_f32 v134, v10
    s_waitcnt lgkmcnt(5)
    v_mfma_f32_16x16x32_bf16 v[120:123], a[24:27], a[28:31], v[120:123]
    ds_read_b128 a[20:23], v145 offset:16384
    v_exp_f32 v135, v11
    s_waitcnt lgkmcnt(4)
    v_mfma_f32_16x16x32_bf16 v[124:127], a[0:3], a[28:31], v[124:127]
    ds_read_b128 a[24:27], v144 offset:16640
    v_add_f32 v141, v141, v134
    v_add_f32 v141, v141, v135
    s_waitcnt lgkmcnt(4)
    v_mfma_f32_16x16x32_bf16 v[120:123], a[4:7], a[8:11], v[120:123]
    ds_read_b128 a[28:31], v145 offset:16640
    v_cvt_pk_bf16_f32 v117, v134, v135
    v_exp_f32 v132, v12
    s_waitcnt lgkmcnt(3)
    v_mfma_f32_16x16x32_bf16 v[124:127], a[12:15], a[8:11], v[124:127]
    ds_read_b128 a[0:3], v144 offset:16896
    v_exp_f32 v133, v13
    v_mfma_f32_32x32x16_bf16 v[16:31], a[16:19], v[156:159], v[32:47]
    ds_read_b128 a[4:7], v145 offset:16896
    v_add_f32 v141, v141, v132
    v_add_f32 v141, v141, v133
    v_cvt_pk_bf16_f32 v118, v132, v133
    v_exp_f32 v134, v14
    s_waitcnt lgkmcnt(3)
    v_mfma_f32_32x32x16_bf16 v[16:31], a[20:23], v[160:163], v[16:31]
    ds_read_b128 a[8:11], v144 offset:17152
    v_exp_f32 v135, v15
    v_add_f32 v141, v141, v134
    v_add_f32 v141, v141, v135
    v_cvt_pk_bf16_f32 v119, v134, v135
    v_mfma_f32_32x32x16_bf16 v[16:31], a[24:27], v[164:167], v[16:31]
    ds_read_b128 a[12:15], v145 offset:17152
    v_cmp_nge_f32 vcc, 0x44800000, v141
    v_max3_f32 v154, v120, v121, v122
    v_max3_f32 v154, v154, v123, v124
    v_max3_f32 v154, v154, v125, v126
    v_max_f32 v154, v154, v127
    v_mov_b32 v155, v154
    s_waitcnt lgkmcnt(2)
    v_mfma_f32_32x32x16_bf16 v[16:31], a[28:31], v[168:171], v[16:31]
    v_permlane32_swap_b32 v154, v155
    v_max_f32 v154, v154, v155
    v_mov_b32 v155, v154
    s_nop 1
    v_permlane16_swap_b32 v154, v155
    v_max_f32 v154, v154, v155
    v_mfma_f32_32x32x16_bf16 v[16:31], a[0:3], v[172:175], v[16:31]
    ds_read_b64_tr_b16 a[16:17], v146 offset:0
    ds_read_b64_tr_b16 a[18:19], v146 offset:2048
    v_sub_f32 v136, 0, v154
    v_sub_f32 v137, 0, v154
    v_sub_f32 v138, 0, v154
    v_sub_f32 v139, 0, v154
    v_sub_f32 v120, v120, v154
    v_sub_f32 v121, v121, v154
    v_mfma_f32_32x32x16_bf16 v[16:31], a[4:7], v[176:179], v[16:31]
    ds_read_b64_tr_b16 a[20:21], v146 offset:256
    ds_read_b64_tr_b16 a[22:23], v146 offset:2304
    v_sub_f32 v122, v122, v154
    v_sub_f32 v123, v123, v154
    v_sub_f32 v124, v124, v154
    v_sub_f32 v125, v125, v154
    v_sub_f32 v126, v126, v154
    s_waitcnt lgkmcnt(2)
    v_mfma_f32_32x32x16_bf16 v[16:31], a[8:11], v[180:183], v[16:31]
    ds_read_b64_tr_b16 a[24:25], v146 offset:512
    ds_read_b64_tr_b16 a[26:27], v146 offset:2560
    v_sub_f32 v127, v127, v154
    v_exp_f32 v154, v120
    v_exp_f32 v155, v121
    s_nop 0
    v_add_f32 v143, v154, v155
    v_mfma_f32_32x32x16_bf16 v[16:31], a[12:15], v[184:187], v[16:31]
    ds_read_b64_tr_b16 a[28:29], v146 offset:768
    ds_read_b64_tr_b16 a[30:31], v146 offset:2816
    v_cvt_pk_bf16_f32 v128, v154, v155
    v_exp_f32 v154, v122
    v_exp_f32 v155, v123
    s_cbranch_vccnz L_rc_61
L_rb_62:
    v_add_f32 v140, v140, v141
    ds_read_b64_tr_b16 a[0:1], v146 offset:4096
    ds_read_b64_tr_b16 a[2:3], v146 offset:6144
    v_mfma_f32_32x32x16_bf16 v[48:63], a[16:19], v[112:115], v[48:63]
    ds_read_b64_tr_b16 a[4:5], v146 offset:4352
    ds_read_b64_tr_b16 a[6:7], v146 offset:6400
    v_exp_f32 v132, v16
    v_exp_f32 v133, v17
    s_nop 0
    v_add_f32 v141, v132, v133
    v_add_f32 v143, v143, v154
    s_waitcnt lgkmcnt(4)
    v_mfma_f32_32x32x16_bf16 v[64:79], a[20:23], v[112:115], v[64:79]
    ds_read_b64_tr_b16 a[8:9], v146 offset:4608
    ds_read_b64_tr_b16 a[10:11], v146 offset:6656
    v_add_f32 v143, v143, v155
    v_cvt_pk_bf16_f32 v129, v154, v155
    v_exp_f32 v154, v124
    v_exp_f32 v155, v125
    v_mfma_f32_32x32x16_bf16 v[80:95], a[24:27], v[112:115], v[80:95]
    ds_read_b64_tr_b16 a[12:13], v146 offset:4864
    ds_read_b64_tr_b16 a[14:15], v146 offset:6912
    v_add_f32 v143, v143, v154
    v_add_f32 v143, v143, v155
    v_cvt_pk_bf16_f32 v130, v154, v155
    v_exp_f32 v154, v126
    v_mfma_f32_32x32x16_bf16 v[96:111], a[28:31], v[112:115], v[96:111]
    v_cvt_pk_bf16_f32 v112, v132, v133
    v_exp_f32 v134, v18
    v_exp_f32 v135, v19
    s_waitcnt lgkmcnt(2)
    v_mfma_f32_32x32x16_bf16 v[48:63], a[0:3], v[116:119], v[48:63]
    ds_read_b128 a[0:3], v144 offset:32768
    v_add_f32 v141, v141, v134
    v_add_f32 v141, v141, v135
    v_cvt_pk_bf16_f32 v113, v134, v135
    v_exp_f32 v132, v20
    v_mfma_f32_32x32x16_bf16 v[64:79], a[4:7], v[116:119], v[64:79]
    ds_read_b128 a[4:7], v145 offset:32768
    v_exp_f32 v133, v21
    v_add_f32 v141, v141, v132
    v_add_f32 v141, v141, v133
    v_cvt_pk_bf16_f32 v114, v132, v133
    v_exp_f32 v134, v22
    v_mfma_f32_32x32x16_bf16 v[80:95], a[8:11], v[116:119], v[80:95]
    ds_read_b128 a[8:11], v144 offset:33024
    v_exp_f32 v135, v23
    v_add_f32 v141, v141, v134
    v_add_f32 v141, v141, v135
    v_cvt_pk_bf16_f32 v115, v134, v135
    v_exp_f32 v155, v127
    v_add_f32 v143, v143, v154
    v_add_f32 v143, v143, v155
    v_cvt_pk_bf16_f32 v131, v154, v155
    s_waitcnt lgkmcnt(1)
    v_mfma_f32_32x32x16_bf16 v[96:111], a[12:15], v[116:119], v[96:111]
    ds_read_b128 a[12:15], v145 offset:33024
    v_cmp_nge_f32 vcc, 0x44800000, v143
    s_cbranch_vccnz L_rc_63
L_rb_64:
    v_add_f32 v142, v142, v143
    s_waitcnt vmcnt(0)
    s_barrier
L_loop2:
    s_waitcnt lgkmcnt(3)
    v_mfma_f32_32x32x16_bf16 v[0:15], a[0:3], v[156:159], v[32:47]
    ds_read_b128 a[16:19], v144 offset:33280
    ds_read_b128 a[20:23], v145 offset:33280
    v_exp_f32 v132, v24
    s_waitcnt lgkmcnt(4)
    v_mfma_f32_32x32x16_bf16 v[0:15], a[4:7], v[160:163], v[0:15]
    ds_read_b128 a[24:27], v144 offset:33536
    v_exp_f32 v133, v25
    v_add_f32 v141, v141, v132
    v_add_f32 v141, v141, v133
    s_waitcnt lgkmcnt(4)
    v_mfma_f32_32x32x16_bf16 v[0:15], a[8:11], v[164:167], v[0:15]
    ds_read_b128 a[28:31], v145 offset:33536
    v_cvt_pk_bf16_f32 v116, v132, v133
    v_exp_f32 v134, v26
    s_waitcnt lgkmcnt(3)
    v_mfma_f32_32x32x16_bf16 v[0:15], a[12:15], v[168:171], v[0:15]
    v_exp_f32 v135, v27
    v_add_f32 v141, v141, v134
    v_mfma_f32_32x32x16_bf16 v[0:15], a[16:19], v[172:175], v[0:15]
    ds_read_b64_tr_b16 a[0:1], v146 offset:16384
    ds_read_b64_tr_b16 a[2:3], v146 offset:18432
    v_add_f32 v141, v141, v135
    v_cvt_pk_bf16_f32 v117, v134, v135
    s_waitcnt lgkmcnt(3)
    v_mfma_f32_32x32x16_bf16 v[0:15], a[20:23], v[176:179], v[0:15]
    ds_read_b64_tr_b16 a[4:5], v146 offset:16640
    ds_read_b64_tr_b16 a[6:7], v146 offset:18688
    v_exp_f32 v132, v28
    v_exp_f32 v133, v29
    v_mfma_f32_32x32x16_bf16 v[0:15], a[24:27], v[180:183], v[0:15]
    ds_read_b64_tr_b16 a[8:9], v146 offset:16896
    ds_read_b64_tr_b16 a[10:11], v146 offset:18944
    v_add_f32 v141, v141, v132
    v_add_f32 v141, v141, v133
    s_waitcnt lgkmcnt(4)
    v_mfma_f32_32x32x16_bf16 v[0:15], a[28:31], v[184:187], v[0:15]
    v_cvt_pk_bf16_f32 v118, v132, v133
    v_exp_f32 v134, v30
    v_exp_f32 v135, v31
    v_add_f32 v141, v141, v134
    v_add_f32 v141, v141, v135
    v_cvt_pk_bf16_f32 v119, v134, v135
    v_cmp_nge_f32 vcc, 0x44800000, v141
    ds_read_b64_tr_b16 a[12:13], v146 offset:17152
    ds_read_b64_tr_b16 a[14:15], v146 offset:19200
    s_cbranch_vccnz L_rc_77
L_rb_78:
    v_add_f32 v140, v140, v141
    ds_read_b64_tr_b16 a[16:17], v146 offset:20480
    ds_read_b64_tr_b16 a[18:19], v146 offset:22528
    v_mfma_f32_32x32x16_bf16 v[48:63], a[0:3], v[112:115], v[48:63]
    ds_read_b64_tr_b16 a[20:21], v146 offset:20736
    ds_read_b64_tr_b16 a[22:23], v146 offset:22784
    s_waitcnt lgkmcnt(6)
    v_mfma_f32_32x32x16_bf16 v[64:79], a[4:7], v[112:115], v[64:79]
    ds_read_b64_tr_b16 a[24:25], v146 offset:20992
    ds_read_b64_tr_b16 a[26:27], v146 offset:23040
    v_mfma_f32_32x32x16_bf16 v[80:95], a[8:11], v[112:115], v[80:95]
    ds_read_b64_tr_b16 a[28:29], v146 offset:21248
    ds_read_b64_tr_b16 a[30:31], v146 offset:23296
    v_exp_f32 v132, v0
    v_exp_f32 v133, v1
    s_waitcnt lgkmcnt(7)
    v_mfma_f32_32x32x16_bf16 v[96:111], a[12:15], v[112:115], v[96:111]
    ds_read_b64_tr_b16 a[0:1], v148 offset:16384
    ds_read_b64_tr_b16 a[2:3], v148 offset:20480
    v_add_f32 v141, v132, v133
    v_cvt_pk_bf16_f32 v112, v132, v133
    s_waitcnt lgkmcnt(6)
    v_mfma_f32_32x32x16_bf16 v[48:63], a[16:19], v[116:119], v[48:63]
    ds_read_b64_tr_b16 a[4:5], v149 offset:16384
    ds_read_b64_tr_b16 a[6:7], v149 offset:20480
    v_exp_f32 v134, v2
    v_mfma_f32_32x32x16_bf16 v[64:79], a[20:23], v[116:119], v[64:79]
    ds_read_b64_tr_b16 a[8:9], v148 offset:16640
    ds_read_b64_tr_b16 a[10:11], v148 offset:20736
    v_exp_f32 v135, v3
    v_add_f32 v141, v141, v134
    v_add_f32 v141, v141, v135
    s_waitcnt lgkmcnt(4)
    v_mfma_f32_32x32x16_bf16 v[80:95], a[24:27], v[116:119], v[80:95]
    ds_read_b64_tr_b16 a[12:13], v149 offset:16640
    ds_read_b64_tr_b16 a[14:15], v149 offset:20736
    v_cvt_pk_bf16_f32 v113, v134, v135
    v_exp_f32 v132, v4
    v_mfma_f32_32x32x16_bf16 v[96:111], a[28:31], v[116:119], v[96:111]
    ds_read_b64_tr_b16 a[16:17], v148 offset:16896
    ds_read_b64_tr_b16 a[18:19], v148 offset:20992
    v_exp_f32 v133, v5
    v_add_f32 v141, v141, v132
    v_mfma_f32_16x16x32_bf16 a[32:35], a[0:3], v[128:131], a[32:35]
    ds_read_b64_tr_b16 a[20:21], v149 offset:16896
    ds_read_b64_tr_b16 a[22:23], v149 offset:20992
    v_add_f32 v141, v141, v133
    s_waitcnt lgkmcnt(6)
    v_mfma_f32_16x16x32_bf16 a[36:39], a[4:7], v[128:131], a[36:39]
    ds_read_b64_tr_b16 a[24:25], v148 offset:17152
    ds_read_b64_tr_b16 a[26:27], v148 offset:21248
    v_cvt_pk_bf16_f32 v114, v132, v133
    v_mfma_f32_16x16x32_bf16 a[40:43], a[8:11], v[128:131], a[40:43]
    ds_read_b64_tr_b16 a[28:29], v149 offset:17152
    ds_read_b64_tr_b16 a[30:31], v149 offset:21248
    v_exp_f32 v134, v6
    s_waitcnt lgkmcnt(6)
    v_mfma_f32_16x16x32_bf16 a[44:47], a[12:15], v[128:131], a[44:47]
    ds_read_b128 a[0:3], v147 offset:49152
    ds_read_b128 a[4:7], v150 offset:0
    v_mfma_f32_16x16x32_bf16 a[48:51], a[16:19], v[128:131], a[48:51]
    ds_read_b128 a[8:11], v147 offset:53248
    v_exp_f32 v135, v7
    s_waitcnt lgkmcnt(6)
    v_mfma_f32_16x16x32_bf16 a[52:55], a[20:23], v[128:131], a[52:55]
    ds_read_b128 a[12:15], v147 offset:49408
    v_add_f32 v141, v141, v134
    s_waitcnt lgkmcnt(5)
    v_mfma_f32_16x16x32_bf16 a[56:59], a[24:27], v[128:131], a[56:59]
    v_add_f32 v141, v141, v135
    v_cvt_pk_bf16_f32 v115, v134, v135
    s_waitcnt lgkmcnt(4)
    v_mfma_f32_16x16x32_bf16 a[60:63], a[28:31], v[128:131], a[60:63]
    s_barrier
    s_waitcnt lgkmcnt(2)
    v_mfma_f32_16x16x32_bf16 v[120:123], a[0:3], a[4:7], v[136:139]
    ds_read_b128 a[16:19], v150 offset:1024
    ds_read_b128 a[20:23], v147 offset:53504
    ds_read_b128 a[24:27], v147 offset:49664
    v_exp_f32 v132, v8
    s_waitcnt lgkmcnt(3)
    v_mfma_f32_16x16x32_bf16 v[124:127], a[8:11], a[4:7], v[136:139]
    ds_read_b128 a[28:31], v150 offset:2048
    ds_read_b128 a[0:3], v147 offset:53760
    ds_read_b128 a[4:7], v147 offset:49920
    v_exp_f32 v133, v9
    s_waitcnt lgkmcnt(5)
    v_mfma_f32_16x16x32_bf16 v[120:123], a[12:15], a[16:19], v[120:123]
    ds_read_b128 a[8:11], v150 offset:3072
    ds_read_b128 a[12:15], v147 offset:54016
    v_add_f32 v141, v141, v132
    s_waitcnt lgkmcnt(6)
    v_mfma_f32_16x16x32_bf16 v[124:127], a[20:23], a[16:19], v[124:127]
    ds_read_b128 a[16:19], v144 offset:49152
    v_add_f32 v141, v141, v133
    v_cvt_pk_bf16_f32 v116, v132, v133
    s_waitcnt lgkmcnt(5)
    v_mfma_f32_16x16x32_bf16 v[120:123], a[24:27], a[28:31], v[120:123]
    ds_read_b128 a[20:23], v145 offset:49152
    v_exp_f32 v134, v10
    s_waitcnt lgkmcnt(4)
    v_mfma_f32_16x16x32_bf16 v[124:127], a[0:3], a[28:31], v[124:127]
    ds_read_b128 a[24:27], v144 offset:49408
    v_exp_f32 v135, v11
    s_waitcnt lgkmcnt(3)
    v_mfma_f32_16x16x32_bf16 v[120:123], a[4:7], a[8:11], v[120:123]
    ds_read_b128 a[28:31], v145 offset:49408
    v_add_f32 v141, v141, v134
    v_mfma_f32_16x16x32_bf16 v[124:127], a[12:15], a[8:11], v[124:127]
    ds_read_b128 a[0:3], v144 offset:49664
    v_add_f32 v141, v141, v135
    v_cvt_pk_bf16_f32 v117, v134, v135
    s_waitcnt lgkmcnt(3)
    v_mfma_f32_32x32x16_bf16 v[16:31], a[16:19], v[156:159], v[32:47]
    ds_read_b128 a[4:7], v145 offset:49664
    v_exp_f32 v132, v12
    v_exp_f32 v133, v13
    v_mfma_f32_32x32x16_bf16 v[16:31], a[20:23], v[160:163], v[16:31]
    ds_read_b128 a[8:11], v144 offset:49920
    v_add_f32 v141, v141, v132
    v_add_f32 v141, v141, v133
    v_cvt_pk_bf16_f32 v118, v132, v133
    v_exp_f32 v134, v14
    s_waitcnt lgkmcnt(2)
    v_mfma_f32_32x32x16_bf16 v[16:31], a[24:27], v[164:167], v[16:31]
    ds_read_b128 a[12:15], v145 offset:49920
    v_exp_f32 v135, v15
    v_add_f32 v141, v141, v134
    v_add_f32 v141, v141, v135
    v_mfma_f32_32x32x16_bf16 v[16:31], a[28:31], v[168:171], v[16:31]
    v_cvt_pk_bf16_f32 v119, v134, v135
    v_cmp_nge_f32 vcc, 0x44800000, v141
    v_exp_f32 v154, v120
    v_mfma_f32_32x32x16_bf16 v[16:31], a[0:3], v[172:175], v[16:31]
    ds_read_b64_tr_b16 a[16:17], v146 offset:32768
    ds_read_b64_tr_b16 a[18:19], v146 offset:34816
    v_exp_f32 v155, v121
    s_nop 0
    v_add_f32 v143, v154, v155
    v_cvt_pk_bf16_f32 v128, v154, v155
    s_waitcnt lgkmcnt(2)
    v_mfma_f32_32x32x16_bf16 v[16:31], a[4:7], v[176:179], v[16:31]
    ds_read_b64_tr_b16 a[20:21], v146 offset:33024
    ds_read_b64_tr_b16 a[22:23], v146 offset:35072
    v_exp_f32 v154, v122
    v_exp_f32 v155, v123
    v_add_f32 v143, v143, v154
    v_mfma_f32_32x32x16_bf16 v[16:31], a[8:11], v[180:183], v[16:31]
    ds_read_b64_tr_b16 a[24:25], v146 offset:33280
    ds_read_b64_tr_b16 a[26:27], v146 offset:35328
    v_add_f32 v143, v143, v155
    v_cvt_pk_bf16_f32 v129, v154, v155
    v_exp_f32 v154, v124
    v_mfma_f32_32x32x16_bf16 v[16:31], a[12:15], v[184:187], v[16:31]
    ds_read_b64_tr_b16 a[28:29], v146 offset:33536
    ds_read_b64_tr_b16 a[30:31], v146 offset:35584
    v_exp_f32 v155, v125
    v_add_f32 v143, v143, v154
    v_add_f32 v143, v143, v155
    s_cbranch_vccnz L_rc_79
L_rb_80:
    v_add_f32 v140, v140, v141
    ds_read_b64_tr_b16 a[0:1], v146 offset:36864
    ds_read_b64_tr_b16 a[2:3], v146 offset:38912
    s_waitcnt lgkmcnt(4)
    v_mfma_f32_32x32x16_bf16 v[48:63], a[16:19], v[112:115], v[48:63]
    ds_read_b64_tr_b16 a[4:5], v146 offset:37120
    ds_read_b64_tr_b16 a[6:7], v146 offset:39168
    v_exp_f32 v132, v16
    v_exp_f32 v133, v17
    s_nop 0
    v_add_f32 v141, v132, v133
    v_mfma_f32_32x32x16_bf16 v[64:79], a[20:23], v[112:115], v[64:79]
    ds_read_b64_tr_b16 a[8:9], v146 offset:37376
    ds_read_b64_tr_b16 a[10:11], v146 offset:39424
    v_cvt_pk_bf16_f32 v130, v154, v155
    v_exp_f32 v154, v126
    v_exp_f32 v155, v127
    v_mfma_f32_32x32x16_bf16 v[80:95], a[24:27], v[112:115], v[80:95]
    ds_read_b64_tr_b16 a[12:13], v146 offset:37632
    ds_read_b64_tr_b16 a[14:15], v146 offset:39680
    v_add_f32 v143, v143, v154
    v_add_f32 v143, v143, v155
    v_cvt_pk_bf16_f32 v131, v154, v155
    s_waitcnt lgkmcnt(4)
    v_mfma_f32_32x32x16_bf16 v[96:111], a[28:31], v[112:115], v[96:111]
    v_cvt_pk_bf16_f32 v112, v132, v133
    v_exp_f32 v134, v18
    v_exp_f32 v135, v19
    v_mfma_f32_32x32x16_bf16 v[48:63], a[0:3], v[116:119], v[48:63]
    ds_read_b128 a[0:3], v144 offset:0
    v_add_f32 v141, v141, v134
    v_add_f32 v141, v141, v135
    v_cvt_pk_bf16_f32 v113, v134, v135
    v_exp_f32 v132, v20
    v_mfma_f32_32x32x16_bf16 v[64:79], a[4:7], v[116:119], v[64:79]
    ds_read_b128 a[4:7], v145 offset:0
    v_exp_f32 v133, v21
    v_add_f32 v141, v141, v132
    s_waitcnt lgkmcnt(2)
    v_mfma_f32_32x32x16_bf16 v[80:95], a[8:11], v[116:119], v[80:95]
    ds_read_b128 a[8:11], v144 offset:256
    v_add_f32 v141, v141, v133
    v_cvt_pk_bf16_f32 v114, v132, v133
    v_exp_f32 v134, v22
    v_exp_f32 v135, v23
    v_add_f32 v141, v141, v134
    v_add_f32 v141, v141, v135
    v_cvt_pk_bf16_f32 v115, v134, v135
    v_mfma_f32_32x32x16_bf16 v[96:111], a[12:15], v[116:119], v[96:111]
    ds_read_b128 a[12:15], v145 offset:256
    v_cmp_nge_f32 vcc, 0x44800000, v143
    s_cbranch_vccnz L_rc_81
L_rb_82:
    v_add_f32 v142, v142, v143
    s_barrier
    s_waitcnt lgkmcnt(1)
    v_mfma_f32_32x32x16_bf16 v[0:15], a[0:3], v[156:159], v[32:47]
    ds_read_b128 a[16:19], v144 offset:512
    ds_read_b128 a[20:23], v145 offset:512
    v_exp_f32 v132, v24
    v_mfma_f32_32x32x16_bf16 v[0:15], a[4:7], v[160:163], v[0:15]
    ds_read_b128 a[24:27], v144 offset:768
    v_exp_f32 v133, v25
    v_add_f32 v141, v141, v132
    v_add_f32 v141, v141, v133
    v_mfma_f32_32x32x16_bf16 v[0:15], a[8:11], v[164:167], v[0:15]
    ds_read_b128 a[28:31], v145 offset:768
    v_cvt_pk_bf16_f32 v116, v132, v133
    v_exp_f32 v134, v26
    s_waitcnt lgkmcnt(4)
    v_mfma_f32_32x32x16_bf16 v[0:15], a[12:15], v[168:171], v[0:15]
    v_exp_f32 v135, v27
    v_add_f32 v141, v141, v134
    s_waitcnt lgkmcnt(2)
    v_mfma_f32_32x32x16_bf16 v[0:15], a[16:19], v[172:175], v[0:15]
    ds_read_b64_tr_b16 a[0:1], v146 offset:49152
    ds_read_b64_tr_b16 a[2:3], v146 offset:51200
    v_add_f32 v141, v141, v135
    v_cvt_pk_bf16_f32 v117, v134, v135
    v_mfma_f32_32x32x16_bf16 v[0:15], a[20:23], v[176:179], v[0:15]
    ds_read_b64_tr_b16 a[4:5], v146 offset:49408
    ds_read_b64_tr_b16 a[6:7], v146 offset:51456
    v_exp_f32 v132, v28
    v_exp_f32 v133, v29
    s_waitcnt lgkmcnt(4)
    v_mfma_f32_32x32x16_bf16 v[0:15], a[24:27], v[180:183], v[0:15]
    ds_read_b64_tr_b16 a[8:9], v146 offset:49664
    ds_read_b64_tr_b16 a[10:11], v146 offset:51712
    v_add_f32 v141, v141, v132
    v_add_f32 v141, v141, v133
    v_mfma_f32_32x32x16_bf16 v[0:15], a[28:31], v[184:187], v[0:15]
    v_cvt_pk_bf16_f32 v118, v132, v133
    v_exp_f32 v134, v30
    v_exp_f32 v135, v31
    v_add_f32 v141, v141, v134
    v_add_f32 v141, v141, v135
    v_cvt_pk_bf16_f32 v119, v134, v135
    v_cmp_nge_f32 vcc, 0x44800000, v141
    ds_read_b64_tr_b16 a[12:13], v146 offset:49920
    ds_read_b64_tr_b16 a[14:15], v146 offset:51968
    s_cbranch_vccnz L_rc_83
L_rb_84:
    v_add_f32 v140, v140, v141
    ds_read_b64_tr_b16 a[16:17], v146 offset:53248
    ds_read_b64_tr_b16 a[18:19], v146 offset:55296
    s_waitcnt lgkmcnt(4)
    v_mfma_f32_32x32x16_bf16 v[48:63], a[0:3], v[112:115], v[48:63]
    ds_read_b64_tr_b16 a[20:21], v146 offset:53504
    ds_read_b64_tr_b16 a[22:23], v146 offset:55552
    v_mfma_f32_32x32x16_bf16 v[64:79], a[4:7], v[112:115], v[64:79]
    ds_read_b64_tr_b16 a[24:25], v146 offset:53760
    ds_read_b64_tr_b16 a[26:27], v146 offset:55808
    v_mfma_f32_32x32x16_bf16 v[80:95], a[8:11], v[112:115], v[80:95]
    ds_read_b64_tr_b16 a[28:29], v146 offset:54016
    ds_read_b64_tr_b16 a[30:31], v146 offset:56064
    v_exp_f32 v132, v0
    v_exp_f32 v133, v1
    s_waitcnt lgkmcnt(7)
    v_mfma_f32_32x32x16_bf16 v[96:111], a[12:15], v[112:115], v[96:111]
    ds_read_b64_tr_b16 a[0:1], v148 offset:49152
    ds_read_b64_tr_b16 a[2:3], v148 offset:53248
    v_add_f32 v141, v132, v133
    v_cvt_pk_bf16_f32 v112, v132, v133
    s_waitcnt lgkmcnt(6)
    v_mfma_f32_32x32x16_bf16 v[48:63], a[16:19], v[116:119], v[48:63]
    ds_read_b64_tr_b16 a[4:5], v149 offset:49152
    ds_read_b64_tr_b16 a[6:7], v149 offset:53248
    v_exp_f32 v134, v2
    v_mfma_f32_32x32x16_bf16 v[64:79], a[20:23], v[116:119], v[64:79]
    ds_read_b64_tr_b16 a[8:9], v148 offset:49408
    ds_read_b64_tr_b16 a[10:11], v148 offset:53504
    v_exp_f32 v135, v3
    v_add_f32 v141, v141, v134
    v_add_f32 v141, v141, v135
    s_waitcnt lgkmcnt(4)
    v_mfma_f32_32x32x16_bf16 v[80:95], a[24:27], v[116:119], v[80:95]
    ds_read_b64_tr_b16 a[12:13], v149 offset:49408
    ds_read_b64_tr_b16 a[14:15], v149 offset:53504
    v_cvt_pk_bf16_f32 v113, v134, v135
    v_exp_f32 v132, v4
    v_mfma_f32_32x32x16_bf16 v[96:111], a[28:31], v[116:119], v[96:111]
    ds_read_b64_tr_b16 a[16:17], v148 offset:49664
    ds_read_b64_tr_b16 a[18:19], v148 offset:53760
    v_exp_f32 v133, v5
    v_add_f32 v141, v141, v132
    v_mfma_f32_16x16x32_bf16 a[32:35], a[0:3], v[128:131], a[32:35]
    ds_read_b64_tr_b16 a[20:21], v149 offset:49664
    ds_read_b64_tr_b16 a[22:23], v149 offset:53760
    v_add_f32 v141, v141, v133
    s_waitcnt lgkmcnt(6)
    v_mfma_f32_16x16x32_bf16 a[36:39], a[4:7], v[128:131], a[36:39]
    ds_read_b64_tr_b16 a[24:25], v148 offset:49920
    ds_read_b64_tr_b16 a[26:27], v148 offset:54016
    v_cvt_pk_bf16_f32 v114, v132, v133
    v_mfma_f32_16x16x32_bf16 a[40:43], a[8:11], v[128:131], a[40:43]
    ds_read_b64_tr_b16 a[28:29], v149 offset:49920
    ds_read_b64_tr_b16 a[30:31], v149 offset:54016
    v_exp_f32 v134, v6
    s_waitcnt lgkmcnt(6)
    v_mfma_f32_16x16x32_bf16 a[44:47], a[12:15], v[128:131], a[44:47]
    ds_read_b128 a[0:3], v147 offset:16384
    ds_read_b128 a[4:7], v150 offset:0
    v_mfma_f32_16x16x32_bf16 a[48:51], a[16:19], v[128:131], a[48:51]
    ds_read_b128 a[8:11], v147 offset:20480
    v_exp_f32 v135, v7
    s_waitcnt lgkmcnt(6)
    v_mfma_f32_16x16x32_bf16 a[52:55], a[20:23], v[128:131], a[52:55]
    ds_read_b128 a[12:15], v147 offset:16640
    v_add_f32 v141, v141, v134
    s_waitcnt lgkmcnt(5)
    v_mfma_f32_16x16x32_bf16 a[56:59], a[24:27], v[128:131], a[56:59]
    v_add_f32 v141, v141, v135
    v_cvt_pk_bf16_f32 v115, v134, v135
    s_waitcnt lgkmcnt(4)
    v_mfma_f32_16x16x32_bf16 a[60:63], a[28:31], v[128:131], a[60:63]
    s_barrier
    s_waitcnt lgkmcnt(2)
    v_mfma_f32_16x16x32_bf16 v[120:123], a[0:3], a[4:7], v[136:139]
    ds_read_b128 a[16:19], v150 offset:1024
    ds_read_b128 a[20:23], v147 offset:20736
    ds_read_b128 a[24:27], v147 offset:16896
    v_exp_f32 v132, v8
    s_waitcnt lgkmcnt(3)
    v_mfma_f32_16x16x32_bf16 v[124:127], a[8:11], a[4:7], v[136:139]
    ds_read_b128 a[28:31], v150 offset:2048
    ds_read_b128 a[0:3], v147 offset:20992
    ds_read_b128 a[4:7], v147 offset:17152
    v_exp_f32 v133, v9
    s_waitcnt lgkmcnt(5)
    v_mfma_f32_16x16x32_bf16 v[120:123], a[12:15], a[16:19], v[120:123]
    ds_read_b128 a[8:11], v150 offset:3072
    ds_read_b128 a[12:15], v147 offset:21248
    v_add_f32 v141, v141, v132
    s_waitcnt lgkmcnt(6)
    v_mfma_f32_16x16x32_bf16 v[124:127], a[20:23], a[16:19], v[124:127]
    ds_read_b128 a[16:19], v144 offset:16384
    v_add_f32 v141, v141, v133
    v_cvt_pk_bf16_f32 v116, v132, v133
    s_waitcnt lgkmcnt(5)
    v_mfma_f32_16x16x32_bf16 v[120:123], a[24:27], a[28:31], v[120:123]
    ds_read_b128 a[20:23], v145 offset:16384
    v_exp_f32 v134, v10
    s_waitcnt lgkmcnt(4)
    v_mfma_f32_16x16x32_bf16 v[124:127], a[0:3], a[28:31], v[124:127]
    ds_read_b128 a[24:27], v144 offset:16640
    v_exp_f32 v135, v11
    s_waitcnt lgkmcnt(3)
    v_mfma_f32_16x16x32_bf16 v[120:123], a[4:7], a[8:11], v[120:123]
    ds_read_b128 a[28:31], v145 offset:16640
    v_add_f32 v141, v141, v134
    v_mfma_f32_16x16x32_bf16 v[124:127], a[12:15], a[8:11], v[124:127]
    ds_read_b128 a[0:3], v144 offset:16896
    v_add_f32 v141, v141, v135
    v_cvt_pk_bf16_f32 v117, v134, v135
    s_waitcnt lgkmcnt(3)
    v_mfma_f32_32x32x16_bf16 v[16:31], a[16:19], v[156:159], v[32:47]
    ds_read_b128 a[4:7], v145 offset:16896
    v_exp_f32 v132, v12
    v_exp_f32 v133, v13
    v_mfma_f32_32x32x16_bf16 v[16:31], a[20:23], v[160:163], v[16:31]
    ds_read_b128 a[8:11], v144 offset:17152
    v_add_f32 v141, v141, v132
    v_add_f32 v141, v141, v133
    v_cvt_pk_bf16_f32 v118, v132, v133
    v_exp_f32 v134, v14
    s_waitcnt lgkmcnt(2)
    v_mfma_f32_32x32x16_bf16 v[16:31], a[24:27], v[164:167], v[16:31]
    ds_read_b128 a[12:15], v145 offset:17152
    v_exp_f32 v135, v15
    v_add_f32 v141, v141, v134
    v_add_f32 v141, v141, v135
    v_mfma_f32_32x32x16_bf16 v[16:31], a[28:31], v[168:171], v[16:31]
    v_cvt_pk_bf16_f32 v119, v134, v135
    v_cmp_nge_f32 vcc, 0x44800000, v141
    v_exp_f32 v154, v120
    v_mfma_f32_32x32x16_bf16 v[16:31], a[0:3], v[172:175], v[16:31]
    ds_read_b64_tr_b16 a[16:17], v146 offset:0
    ds_read_b64_tr_b16 a[18:19], v146 offset:2048
    v_exp_f32 v155, v121
    s_nop 0
    v_add_f32 v143, v154, v155
    v_cvt_pk_bf16_f32 v128, v154, v155
    s_waitcnt lgkmcnt(2)
    v_mfma_f32_32x32x16_bf16 v[16:31], a[4:7], v[176:179], v[16:31]
    ds_read_b64_tr_b16 a[20:21], v146 offset:256
    ds_read_b64_tr_b16 a[22:23], v146 offset:2304
    v_exp_f32 v154, v122
    v_exp_f32 v155, v123
    v_add_f32 v143, v143, v154
    v_mfma_f32_32x32x16_bf16 v[16:31], a[8:11], v[180:183], v[16:31]
    ds_read_b64_tr_b16 a[24:25], v146 offset:512
    ds_read_b64_tr_b16 a[26:27], v146 offset:2560
    v_add_f32 v143, v143, v155
    v_cvt_pk_bf16_f32 v129, v154, v155
    v_exp_f32 v154, v124
    v_mfma_f32_32x32x16_bf16 v[16:31], a[12:15], v[184:187], v[16:31]
    ds_read_b64_tr_b16 a[28:29], v146 offset:768
    ds_read_b64_tr_b16 a[30:31], v146 offset:2816
    v_exp_f32 v155, v125
    v_add_f32 v143, v143, v154
    v_add_f32 v143, v143, v155
    s_cbranch_vccnz L_rc_85
L_rb_86:
    v_add_f32 v140, v140, v141
    ds_read_b64_tr_b16 a[0:1], v146 offset:4096
    ds_read_b64_tr_b16 a[2:3], v146 offset:6144
    s_waitcnt lgkmcnt(4)
    v_mfma_f32_32x32x16_bf16 v[48:63], a[16:19], v[112:115], v[48:63]
    ds_read_b64_tr_b16 a[4:5], v146 offset:4352
    ds_read_b64_tr_b16 a[6:7], v146 offset:6400
    v_exp_f32 v132, v16
    v_exp_f32 v133, v17
    s_nop 0
    v_add_f32 v141, v132, v133
    v_mfma_f32_32x32x16_bf16 v[64:79], a[20:23], v[112:115], v[64:79]
    ds_read_b64_tr_b16 a[8:9], v146 offset:4608
    ds_read_b64_tr_b16 a[10:11], v146 offset:6656
    v_cvt_pk_bf16_f32 v130, v154, v155
    v_exp_f32 v154, v126
    v_exp_f32 v155, v127
    v_mfma_f32_32x32x16_bf16 v[80:95], a[24:27], v[112:115], v[80:95]
    ds_read_b64_tr_b16 a[12:13], v146 offset:4864
    ds_read_b64_tr_b16 a[14:15], v146 offset:6912
    v_add_f32 v143, v143, v154
    v_add_f32 v143, v143, v155
    v_cvt_pk_bf16_f32 v131, v154, v155
    s_waitcnt lgkmcnt(4)
    v_mfma_f32_32x32x16_bf16 v[96:111], a[28:31], v[112:115], v[96:111]
    v_cvt_pk_bf16_f32 v112, v132, v133
    v_exp_f32 v134, v18
    v_exp_f32 v135, v19
    v_mfma_f32_32x32x16_bf16 v[48:63], a[0:3], v[116:119], v[48:63]
    ds_read_b128 a[0:3], v144 offset:32768
    v_add_f32 v141, v141, v134
    v_add_f32 v141, v141, v135
    v_cvt_pk_bf16_f32 v113, v134, v135
    v_exp_f32 v132, v20
    v_mfma_f32_32x32x16_bf16 v[64:79], a[4:7], v[116:119], v[64:79]
    ds_read_b128 a[4:7], v145 offset:32768
    v_exp_f32 v133, v21
    v_add_f32 v141, v141, v132
    s_waitcnt lgkmcnt(2)
    v_mfma_f32_32x32x16_bf16 v[80:95], a[8:11], v[116:119], v[80:95]
    ds_read_b128 a[8:11], v144 offset:33024
    v_add_f32 v141, v141, v133
    v_cvt_pk_bf16_f32 v114, v132, v133
    v_exp_f32 v134, v22
    v_exp_f32 v135, v23
    v_add_f32 v141, v141, v134
    v_add_f32 v141, v141, v135
    v_cvt_pk_bf16_f32 v115, v134, v135
    v_mfma_f32_32x32x16_bf16 v[96:111], a[12:15], v[116:119], v[96:111]
    ds_read_b128 a[12:15], v145 offset:33024
    v_cmp_nge_f32 vcc, 0x44800000, v143
    s_cbranch_vccnz L_rc_87
L_rb_88:
    v_add_f32 v142, v142, v143
    s_barrier
    s_sub_u32 s21, s21, 1
    s_cmp_lg_u32 s21, 0
    s_cbranch_scc1 L_loop2
    s_waitcnt lgkmcnt(1)
    v_mfma_f32_32x32x16_bf16 v[0:15], a[0:3], v[156:159], v[32:47]
    ds_read_b128 a[16:19], v144 offset:33280
    ds_read_b128 a[20:23], v145 offset:33280
    v_exp_f32 v132, v24
    v_mfma_f32_32x32x16_bf16 v[0:15], a[4:7], v[160:163], v[0:15]
    ds_read_b128 a[24:27], v144 offset:33536
    v_exp_f32 v133, v25
    v_add_f32 v141, v141, v132
    v_add_f32 v141, v141, v133
    v_mfma_f32_32x32x16_bf16 v[0:15], a[8:11], v[164:167], v[0:15]
    ds_read_b128 a[28:31], v145 offset:33536
    v_cvt_pk_bf16_f32 v116, v132, v133
    v_exp_f32 v134, v26
    s_waitcnt lgkmcnt(4)
    v_mfma_f32_32x32x16_bf16 v[0:15], a[12:15], v[168:171], v[0:15]
    v_exp_f32 v135, v27
    v_add_f32 v141, v141, v134
    s_waitcnt lgkmcnt(2)
    v_mfma_f32_32x32x16_bf16 v[0:15], a[16:19], v[172:175], v[0:15]
    ds_read_b64_tr_b16 a[0:1], v146 offset:16384
    ds_read_b64_tr_b16 a[2:3], v146 offset:18432
    v_add_f32 v141, v141, v135
    v_cvt_pk_bf16_f32 v117, v134, v135
    v_mfma_f32_32x32x16_bf16 v[0:15], a[20:23], v[176:179], v[0:15]
    ds_read_b64_tr_b16 a[4:5], v146 offset:16640
    ds_read_b64_tr_b16 a[6:7], v146 offset:18688
    v_exp_f32 v132, v28
    v_exp_f32 v133, v29
    s_waitcnt lgkmcnt(4)
    v_mfma_f32_32x32x16_bf16 v[0:15], a[24:27], v[180:183], v[0:15]
    ds_read_b64_tr_b16 a[8:9], v146 offset:16896
    ds_read_b64_tr_b16 a[10:11], v146 offset:18944
    v_add_f32 v141, v141, v132
    v_add_f32 v141, v141, v133
    v_mfma_f32_32x32x16_bf16 v[0:15], a[28:31], v[184:187], v[0:15]
    v_cvt_pk_bf16_f32 v118, v132, v133
    v_exp_f32 v134, v30
    v_exp_f32 v135, v31
    v_add_f32 v141, v141, v134
    v_add_f32 v141, v141, v135
    v_cvt_pk_bf16_f32 v119, v134, v135
    v_cmp_nge_f32 vcc, 0x44800000, v141
    ds_read_b64_tr_b16 a[12:13], v146 offset:17152
    ds_read_b64_tr_b16 a[14:15], v146 offset:19200
    s_cbranch_vccnz L_rc_89
L_rb_90:
    v_add_f32 v140, v140, v141
    ds_read_b64_tr_b16 a[16:17], v146 offset:20480
    ds_read_b64_tr_b16 a[18:19], v146 offset:22528
    s_waitcnt lgkmcnt(4)
    v_mfma_f32_32x32x16_bf16 v[48:63], a[0:3], v[112:115], v[48:63]
    ds_read_b64_tr_b16 a[20:21], v146 offset:20736
    ds_read_b64_tr_b16 a[22:23], v146 offset:22784
    v_mfma_f32_32x32x16_bf16 v[64:79], a[4:7], v[112:115], v[64:79]
    ds_read_b64_tr_b16 a[24:25], v146 offset:20992
    ds_read_b64_tr_b16 a[26:27], v146 offset:23040
    v_mfma_f32_32x32x16_bf16 v[80:95], a[8:11], v[112:115], v[80:95]
    ds_read_b64_tr_b16 a[28:29], v146 offset:21248
    ds_read_b64_tr_b16 a[30:31], v146 offset:23296
    v_exp_f32 v132, v0
    v_exp_f32 v133, v1
    s_waitcnt lgkmcnt(7)
    v_mfma_f32_32x32x16_bf16 v[96:111], a[12:15], v[112:115], v[96:111]
    ds_read_b64_tr_b16 a[0:1], v148 offset:16384
    ds_read_b64_tr_b16 a[2:3], v148 offset:20480
    v_add_f32 v141, v132, v133
    v_cvt_pk_bf16_f32 v112, v132, v133
    s_waitcnt lgkmcnt(6)
    v_mfma_f32_32x32x16_bf16 v[48:63], a[16:19], v[116:119], v[48:63]
    ds_read_b64_tr_b16 a[4:5], v149 offset:16384
    ds_read_b64_tr_b16 a[6:7], v149 offset:20480
    v_exp_f32 v134, v2
    v_mfma_f32_32x32x16_bf16 v[64:79], a[20:23], v[116:119], v[64:79]
    ds_read_b64_tr_b16 a[8:9], v148 offset:16640
    ds_read_b64_tr_b16 a[10:11], v148 offset:20736
    v_exp_f32 v135, v3
    v_add_f32 v141, v141, v134
    v_add_f32 v141, v141, v135
    s_waitcnt lgkmcnt(4)
    v_mfma_f32_32x32x16_bf16 v[80:95], a[24:27], v[116:119], v[80:95]
    ds_read_b64_tr_b16 a[12:13], v149 offset:16640
    ds_read_b64_tr_b16 a[14:15], v149 offset:20736
    v_cvt_pk_bf16_f32 v113, v134, v135
    v_exp_f32 v132, v4
    v_mfma_f32_32x32x16_bf16 v[96:111], a[28:31], v[116:119], v[96:111]
    ds_read_b64_tr_b16 a[16:17], v148 offset:16896
    ds_read_b64_tr_b16 a[18:19], v148 offset:20992
    v_exp_f32 v133, v5
    v_add_f32 v141, v141, v132
    v_mfma_f32_16x16x32_bf16 a[32:35], a[0:3], v[128:131], a[32:35]
    ds_read_b64_tr_b16 a[20:21], v149 offset:16896
    ds_read_b64_tr_b16 a[22:23], v149 offset:20992
    v_add_f32 v141, v141, v133
    s_waitcnt lgkmcnt(6)
    v_mfma_f32_16x16x32_bf16 a[36:39], a[4:7], v[128:131], a[36:39]
    ds_read_b64_tr_b16 a[24:25], v148 offset:17152
    ds_read_b64_tr_b16 a[26:27], v148 offset:21248
    v_cvt_pk_bf16_f32 v114, v132, v133
    v_mfma_f32_16x16x32_bf16 a[40:43], a[8:11], v[128:131], a[40:43]
    ds_read_b64_tr_b16 a[28:29], v149 offset:17152
    ds_read_b64_tr_b16 a[30:31], v149 offset:21248
    v_exp_f32 v134, v6
    s_waitcnt lgkmcnt(6)
    v_mfma_f32_16x16x32_bf16 a[44:47], a[12:15], v[128:131], a[44:47]
    ds_read_b128 a[0:3], v147 offset:49152
    ds_read_b128 a[4:7], v150 offset:0
    v_mfma_f32_16x16x32_bf16 a[48:51], a[16:19], v[128:131], a[48:51]
    ds_read_b128 a[8:11], v147 offset:53248
    v_exp_f32 v135, v7
    s_waitcnt lgkmcnt(6)
    v_mfma_f32_16x16x32_bf16 a[52:55], a[20:23], v[128:131], a[52:55]
    ds_read_b128 a[12:15], v147 offset:49408
    v_add_f32 v141, v141, v134
    s_waitcnt lgkmcnt(5)
    v_mfma_f32_16x16x32_bf16 a[56:59], a[24:27], v[128:131], a[56:59]
    v_add_f32 v141, v141, v135
    v_cvt_pk_bf16_f32 v115, v134, v135
    s_waitcnt lgkmcnt(4)
    v_mfma_f32_16x16x32_bf16 a[60:63], a[28:31], v[128:131], a[60:63]
    s_barrier
    s_waitcnt lgkmcnt(2)
    v_mfma_f32_16x16x32_bf16 v[120:123], a[0:3], a[4:7], v[136:139]
    ds_read_b128 a[16:19], v150 offset:1024
    ds_read_b128 a[20:23], v147 offset:53504
    ds_read_b128 a[24:27], v147 offset:49664
    v_exp_f32 v132, v8
    s_waitcnt lgkmcnt(3)
    v_mfma_f32_16x16x32_bf16 v[124:127], a[8:11], a[4:7], v[136:139]
    ds_read_b128 a[28:31], v150 offset:2048
    ds_read_b128 a[0:3], v147 offset:53760
    ds_read_b128 a[4:7], v147 offset:49920
    v_exp_f32 v133, v9
    s_waitcnt lgkmcnt(5)
    v_mfma_f32_16x16x32_bf16 v[120:123], a[12:15], a[16:19], v[120:123]
    ds_read_b128 a[8:11], v150 offset:3072
    ds_read_b128 a[12:15], v147 offset:54016
    v_add_f32 v141, v141, v132
    s_waitcnt lgkmcnt(6)
    v_mfma_f32_16x16x32_bf16 v[124:127], a[20:23], a[16:19], v[124:127]
    ds_read_b128 a[16:19], v144 offset:49152
    v_add_f32 v141, v141, v133
    v_cvt_pk_bf16_f32 v116, v132, v133
    s_waitcnt lgkmcnt(5)
    v_mfma_f32_16x16x32_bf16 v[120:123], a[24:27], a[28:31], v[120:123]
    ds_read_b128 a[20:23], v145 offset:49152
    v_exp_f32 v134, v10
    s_waitcnt lgkmcnt(4)
    v_mfma_f32_16x16x32_bf16 v[124:127], a[0:3], a[28:31], v[124:127]
    ds_read_b128 a[24:27], v144 offset:49408
    v_exp_f32 v135, v11
    s_waitcnt lgkmcnt(3)
    v_mfma_f32_16x16x32_bf16 v[120:123], a[4:7], a[8:11], v[120:123]
    ds_read_b128 a[28:31], v145 offset:49408
    v_add_f32 v141, v141, v134
    v_mfma_f32_16x16x32_bf16 v[124:127], a[12:15], a[8:11], v[124:127]
    ds_read_b128 a[0:3], v144 offset:49664
    v_add_f32 v141, v141, v135
    v_cvt_pk_bf16_f32 v117, v134, v135
    s_waitcnt lgkmcnt(3)
    v_mfma_f32_32x32x16_bf16 v[16:31], a[16:19], v[156:159], v[32:47]
    ds_read_b128 a[4:7], v145 offset:49664
    v_exp_f32 v132, v12
    v_exp_f32 v133, v13
    v_mfma_f32_32x32x16_bf16 v[16:31], a[20:23], v[160:163], v[16:31]
    ds_read_b128 a[8:11], v144 offset:49920
    v_add_f32 v141, v141, v132
    v_add_f32 v141, v141, v133
    v_cvt_pk_bf16_f32 v118, v132, v133
    v_exp_f32 v134, v14
    s_waitcnt lgkmcnt(2)
    v_mfma_f32_32x32x16_bf16 v[16:31], a[24:27], v[164:167], v[16:31]
    ds_read_b128 a[12:15], v145 offset:49920
    v_exp_f32 v135, v15
    v_add_f32 v141, v141, v134
    v_add_f32 v141, v141, v135
    v_mfma_f32_32x32x16_bf16 v[16:31], a[28:31], v[168:171], v[16:31]
    v_cvt_pk_bf16_f32 v119, v134, v135
    v_cmp_nge_f32 vcc, 0x44800000, v141
    v_exp_f32 v154, v120
    v_mfma_f32_32x32x16_bf16 v[16:31], a[0:3], v[172:175], v[16:31]
    ds_read_b64_tr_b16 a[16:17], v146 offset:32768
    ds_read_b64_tr_b16 a[18:19], v146 offset:34816
    v_exp_f32 v155, v121
    s_nop 0
    v_add_f32 v143, v154, v155
    v_cvt_pk_bf16_f32 v128, v154, v155
    s_waitcnt lgkmcnt(2)
    v_mfma_f32_32x32x16_bf16 v[16:31], a[4:7], v[176:179], v[16:31]
    ds_read_b64_tr_b16 a[20:21], v146 offset:33024
    ds_read_b64_tr_b16 a[22:23], v146 offset:35072
    v_exp_f32 v154, v122
    v_exp_f32 v155, v123
    v_add_f32 v143, v143, v154
    v_mfma_f32_32x32x16_bf16 v[16:31], a[8:11], v[180:183], v[16:31]
    ds_read_b64_tr_b16 a[24:25], v146 offset:33280
    ds_read_b64_tr_b16 a[26:27], v146 offset:35328
    v_add_f32 v143, v143, v155
    v_cvt_pk_bf16_f32 v129, v154, v155
    v_exp_f32 v154, v124
    v_mfma_f32_32x32x16_bf16 v[16:31], a[12:15], v[184:187], v[16:31]
    ds_read_b64_tr_b16 a[28:29], v146 offset:33536
    ds_read_b64_tr_b16 a[30:31], v146 offset:35584
    v_exp_f32 v155, v125
    v_add_f32 v143, v143, v154
    v_add_f32 v143, v143, v155
    s_cbranch_vccnz L_rc_91
L_rb_92:
    v_add_f32 v140, v140, v141
    ds_read_b64_tr_b16 a[0:1], v146 offset:36864
    ds_read_b64_tr_b16 a[2:3], v146 offset:38912
    s_waitcnt lgkmcnt(4)
    v_mfma_f32_32x32x16_bf16 v[48:63], a[16:19], v[112:115], v[48:63]
    ds_read_b64_tr_b16 a[4:5], v146 offset:37120
    ds_read_b64_tr_b16 a[6:7], v146 offset:39168
    v_exp_f32 v132, v16
    v_exp_f32 v133, v17
    s_nop 0
    v_add_f32 v141, v132, v133
    v_mfma_f32_32x32x16_bf16 v[64:79], a[20:23], v[112:115], v[64:79]
    ds_read_b64_tr_b16 a[8:9], v146 offset:37376
    ds_read_b64_tr_b16 a[10:11], v146 offset:39424
    v_cvt_pk_bf16_f32 v130, v154, v155
    v_exp_f32 v154, v126
    v_exp_f32 v155, v127
    v_mfma_f32_32x32x16_bf16 v[80:95], a[24:27], v[112:115], v[80:95]
    ds_read_b64_tr_b16 a[12:13], v146 offset:37632
    ds_read_b64_tr_b16 a[14:15], v146 offset:39680
    v_add_f32 v143, v143, v154
    v_add_f32 v143, v143, v155
    v_cvt_pk_bf16_f32 v131, v154, v155
    s_waitcnt lgkmcnt(4)
    v_mfma_f32_32x32x16_bf16 v[96:111], a[28:31], v[112:115], v[96:111]
    v_cvt_pk_bf16_f32 v112, v132, v133
    v_exp_f32 v134, v18
    v_exp_f32 v135, v19
    v_mfma_f32_32x32x16_bf16 v[48:63], a[0:3], v[116:119], v[48:63]
    v_add_f32 v141, v141, v134
    v_add_f32 v141, v141, v135
    v_cvt_pk_bf16_f32 v113, v134, v135
    v_exp_f32 v132, v20
    v_mfma_f32_32x32x16_bf16 v[64:79], a[4:7], v[116:119], v[64:79]
    v_exp_f32 v133, v21
    v_add_f32 v141, v141, v132
    s_waitcnt lgkmcnt(0)
    v_mfma_f32_32x32x16_bf16 v[80:95], a[8:11], v[116:119], v[80:95]
    v_add_f32 v141, v141, v133
    v_cvt_pk_bf16_f32 v114, v132, v133
    v_exp_f32 v134, v22
    v_exp_f32 v135, v23
    v_add_f32 v141, v141, v134
    v_add_f32 v141, v141, v135
    v_cvt_pk_bf16_f32 v115, v134, v135
    v_mfma_f32_32x32x16_bf16 v[96:111], a[12:15], v[116:119], v[96:111]
    v_cmp_nge_f32 vcc, 0x44800000, v143
    s_cbranch_vccnz L_rc_93
L_rb_94:
    v_add_f32 v142, v142, v143
    s_barrier
    v_and_b32 v150, 0x3ff, v150
    s_lshl_b32 s46, s58, 14
    s_add_u32 s46, s46, 0x10000
    v_add_u32 v144, s46, v150
    v_lshrrev_b32 v187, 1, v150
    s_lshl_b32 s46, s58, 9
    s_add_u32 s46, s46, 0x21000
    v_add_u32 v145, s46, v187
    s_lshl_b32 s46, s58, 13
    s_add_u32 s46, s46, 0x0
    v_add_u32 v147, s46, v150
    ds_read_b64_tr_b16 a[0:1], v148 offset:49152
    ds_read_b64_tr_b16 a[2:3], v148 offset:53248
    ds_read_b64_tr_b16 a[4:5], v149 offset:49152
    ds_read_b64_tr_b16 a[6:7], v149 offset:53248
    ds_read_b64_tr_b16 a[8:9], v148 offset:49408
    ds_read_b64_tr_b16 a[10:11], v148 offset:53504
    ds_read_b64_tr_b16 a[12:13], v149 offset:49408
    ds_read_b64_tr_b16 a[14:15], v149 offset:53504
    ds_read_b64_tr_b16 a[16:17], v148 offset:49664
    ds_read_b64_tr_b16 a[18:19], v148 offset:53760
    ds_read_b64_tr_b16 a[20:21], v149 offset:49664
    ds_read_b64_tr_b16 a[22:23], v149 offset:53760
    ds_read_b64_tr_b16 a[24:25], v148 offset:49920
    ds_read_b64_tr_b16 a[26:27], v148 offset:54016
    s_waitcnt lgkmcnt(12)
    v_mfma_f32_16x16x32_bf16 a[32:35], a[0:3], v[128:131], a[32:35]
    ds_read_b64_tr_b16 a[28:29], v149 offset:49920
    ds_read_b64_tr_b16 a[30:31], v149 offset:54016
    v_exp_f32 v132, v24
    s_waitcnt lgkmcnt(10)
    v_mfma_f32_16x16x32_bf16 a[36:39], a[4:7], v[128:131], a[36:39]
    ds_read_b64_tr_b16 a[0:1], v146 offset:49152
    ds_read_b64_tr_b16 a[2:3], v146 offset:51200
    v_mov_b32 v152, v136
    v_mov_b32 v153, v142
    ds_write_b64 v145, v[152:153] offset:4096
    v_mfma_f32_16x16x32_bf16 a[40:43], a[8:11], v[128:131], a[40:43]
    s_waitcnt lgkmcnt(5)
    v_mfma_f32_16x16x32_bf16 a[44:47], a[12:15], v[128:131], a[44:47]
    ds_read_b64_tr_b16 a[4:5], v146 offset:53248
    ds_read_b64_tr_b16 a[6:7], v146 offset:55296
    v_mfma_f32_16x16x32_bf16 a[48:51], a[16:19], v[128:131], a[48:51]
    ds_read_b64_tr_b16 a[8:9], v146 offset:49408
    ds_read_b64_tr_b16 a[10:11], v146 offset:51456
    v_exp_f32 v133, v25
    v_mfma_f32_16x16x32_bf16 a[52:55], a[20:23], v[128:131], a[52:55]
    ds_read_b64_tr_b16 a[12:13], v146 offset:53504
    ds_read_b64_tr_b16 a[14:15], v146 offset:55552
    v_add_f32 v141, v141, v132
    v_mfma_f32_16x16x32_bf16 a[56:59], a[24:27], v[128:131], a[56:59]
    ds_read_b64_tr_b16 a[16:17], v146 offset:49664
    ds_read_b64_tr_b16 a[18:19], v146 offset:51712
    v_add_f32 v141, v141, v133
    s_waitcnt lgkmcnt(7)
    v_mfma_f32_16x16x32_bf16 a[60:63], a[28:31], v[128:131], a[60:63]
    v_cvt_pk_bf16_f32 v116, v132, v133
    v_exp_f32 v134, v26
    v_exp_f32 v135, v27
    v_add_f32 v141, v141, v134
    v_add_f32 v141, v141, v135
    v_cvt_pk_bf16_f32 v117, v134, v135
    v_exp_f32 v132, v28
    v_exp_f32 v133, v29
    v_add_f32 v141, v141, v132
    v_add_f32 v141, v141, v133
    v_cvt_pk_bf16_f32 v118, v132, v133
    v_exp_f32 v134, v30
    v_exp_f32 v135, v31
    v_add_f32 v141, v141, v134
    v_add_f32 v141, v141, v135
    v_cvt_pk_bf16_f32 v119, v134, v135
    v_cmp_nge_f32 vcc, 0x44800000, v141
    ds_read_b64_tr_b16 a[20:21], v146 offset:53760
    ds_read_b64_tr_b16 a[22:23], v146 offset:55808
    s_cbranch_vccnz L_rc_95
L_rb_96:
    v_add_f32 v140, v140, v141
    ds_read_b64_tr_b16 a[24:25], v146 offset:49920
    ds_read_b64_tr_b16 a[26:27], v146 offset:51968
    v_mov_b32 v154, v32
    v_mov_b32 v155, v140
    ds_write_b64 v145, v[154:155] offset:2048
    v_mfma_f32_32x32x16_bf16 v[48:63], a[0:3], v[112:115], v[48:63]
    ds_read_b64_tr_b16 a[28:29], v146 offset:54016
    ds_read_b64_tr_b16 a[30:31], v146 offset:56064
    s_waitcnt lgkmcnt(7)
    v_mfma_f32_32x32x16_bf16 v[48:63], a[4:7], v[116:119], v[48:63]
    ds_write_b128 v147, a[32:35] offset:0
    ds_write_b128 v147, a[36:39] offset:1024
    ds_write_b128 v147, a[40:43] offset:2048
    ds_write_b128 v147, a[44:47] offset:3072
    ds_write_b128 v147, a[48:51] offset:4096
    ds_write_b128 v147, a[52:55] offset:5120
    ds_write_b128 v147, a[56:59] offset:6144
    v_mfma_f32_32x32x16_bf16 v[64:79], a[8:11], v[112:115], v[64:79]
    v_mfma_f32_32x32x16_bf16 v[64:79], a[12:15], v[116:119], v[64:79]
    v_mfma_f32_32x32x16_bf16 v[80:95], a[16:19], v[112:115], v[80:95]
    s_waitcnt lgkmcnt(8)
    v_mfma_f32_32x32x16_bf16 v[80:95], a[20:23], v[116:119], v[80:95]
    ds_write_b128 v144, v[48:51] offset:0
    ds_write_b128 v144, v[52:55] offset:1024
    ds_write_b128 v144, v[56:59] offset:2048
    ds_write_b128 v144, v[60:63] offset:3072
    s_nop 4
    ds_write_b128 v144, v[64:67] offset:4096
    ds_write_b128 v144, v[68:71] offset:5120
    v_mfma_f32_32x32x16_bf16 v[96:111], a[24:27], v[112:115], v[96:111]
    ds_write_b128 v144, v[72:75] offset:6144
    s_waitcnt lgkmcnt(14)
    ds_write_b128 v144, v[76:79] offset:7168
    s_waitcnt lgkmcnt(14)
    ds_write_b128 v147, a[60:63] offset:7168
    v_mfma_f32_32x32x16_bf16 v[96:111], a[28:31], v[116:119], v[96:111]
    s_waitcnt lgkmcnt(0)
    s_barrier
    ds_read_b64 v[132:133], v145 offset:0
    ds_read_b128 v[0:3], v144 offset:8192
    ds_read_b128 v[4:7], v144 offset:9216
    ds_read_b128 v[8:11], v144 offset:10240
    ds_read_b128 v[12:15], v144 offset:11264
    ds_read_b128 v[16:19], v144 offset:12288
    ds_read_b128 v[20:23], v144 offset:13312
    ds_read_b128 v[24:27], v144 offset:14336
    ds_read_b128 v[28:31], v144 offset:15360
    v_add_u32 v155, 0x22000, v187
    s_lshl_b32 s46, s58, 11
    s_add_u32 s46, s46, 0x400
    v_add_u32 v154, s46, v150
    s_lshl_b32 s46, s20, 12
    s_add_u32 s46, s46, 0x8000
    v_lshrrev_b32 v149, 4, v150
    v_and_b32 v152, 31, v149
    v_and_b32 v148, 7, v149
    v_lshlrev_b32 v152, 7, v152
    v_lshl_or_b32 v152, v148, 4, v152
    v_lshrrev_b32 v153, 5, v149
    v_lshl_or_b32 v152, v153, 3, v152
    v_add_u32 v152, s46, v152
    v_lshrrev_b32 v149, 3, v149
    v_xor_b32 v153, v149, v148
    v_and_b32 v153, 7, v153
    v_lshlrev_b32 v153, 4, v153
    v_lshl_or_b32 v153, v149, 7, v153
    v_add_u32 v153, s46, v153
    s_lshl_b32 s46, s58, 5
    v_add_u32 v149, s46, v149
    v_lshlrev_b32 v149, 8, v149
    v_lshl_or_b32 v148, v148, 4, v149
    v_lshrrev_b32 v149, 4, v150
    v_and_b32 v146, 15, v149
    v_lshrrev_b32 v149, 4, v149
    v_add_u32 v146, 128, v146
    v_lshlrev_b32 v146, 8, v146
    v_lshl_or_b32 v146, v149, 3, v146
    s_lshl_b32 s46, s58, 6
    v_add_u32 v146, s46, v146
    ds_read_b64 v[156:157], v155 offset:0
    ds_read_b64 v[158:159], v155 offset:512
    ds_read_b64 v[160:161], v155 offset:1024
    ds_read_b64 v[162:163], v155 offset:1536
    s_waitcnt lgkmcnt(4)
    v_min_f32 v120, v32, v132
    v_sub_f32 v122, v120, v32
    v_sub_f32 v124, v120, v132
    v_exp_f32 v122, v122
    v_exp_f32 v124, v124
    v_mul_f32 v121, v122, v140
    v_fmac_f32 v121, v124, v133
    v_mov_b32 v123, v121
    s_nop 1
    v_permlane32_swap_b32 v121, v123
    v_add_f32 v121, v121, v123
    v_rcp_f32 v121, v121
    s_nop 0
    v_mul_f32 v122, v122, v121
    v_mul_f32 v124, v124, v121
    v_pk_mul_f32 v[80:81], v[80:81], v[122:123] op_sel_hi:[1,0]
    v_pk_mul_f32 v[82:83], v[82:83], v[122:123] op_sel_hi:[1,0]
    v_pk_mul_f32 v[84:85], v[84:85], v[122:123] op_sel_hi:[1,0]
    v_pk_mul_f32 v[86:87], v[86:87], v[122:123] op_sel_hi:[1,0]
    v_pk_mul_f32 v[88:89], v[88:89], v[122:123] op_sel_hi:[1,0]
    v_pk_mul_f32 v[90:91], v[90:91], v[122:123] op_sel_hi:[1,0]
    v_pk_mul_f32 v[92:93], v[92:93], v[122:123] op_sel_hi:[1,0]
    v_pk_mul_f32 v[94:95], v[94:95], v[122:123] op_sel_hi:[1,0]
    v_pk_fma_f32 v[80:81], v[0:1], v[124:125], v[80:81] op_sel_hi:[1,0,1]
    v_pk_fma_f32 v[82:83], v[2:3], v[124:125], v[82:83] op_sel_hi:[1,0,1]
    v_pk_fma_f32 v[84:85], v[4:5], v[124:125], v[84:85] op_sel_hi:[1,0,1]
    v_pk_fma_f32 v[86:87], v[6:7], v[124:125], v[86:87] op_sel_hi:[1,0,1]
    v_pk_fma_f32 v[88:89], v[8:9], v[124:125], v[88:89] op_sel_hi:[1,0,1]
    v_pk_fma_f32 v[90:91], v[10:11], v[124:125], v[90:91] op_sel_hi:[1,0,1]
    v_pk_fma_f32 v[92:93], v[12:13], v[124:125], v[92:93] op_sel_hi:[1,0,1]
    v_pk_fma_f32 v[94:95], v[14:15], v[124:125], v[94:95] op_sel_hi:[1,0,1]
    ds_read_b128 v[164:167], v154 offset:0
    ds_read_b128 v[168:171], v154 offset:8192
    ds_read_b128 v[172:175], v154 offset:16384
    ds_read_b128 v[176:179], v154 offset:24576
    v_cvt_pk_bf16_f32 v32, v80, v81
    v_cvt_pk_bf16_f32 v33, v82, v83
    v_cvt_pk_bf16_f32 v34, v84, v85
    v_cvt_pk_bf16_f32 v35, v86, v87
    v_cvt_pk_bf16_f32 v36, v88, v89
    v_cvt_pk_bf16_f32 v37, v90, v91
    v_cvt_pk_bf16_f32 v38, v92, v93
    v_cvt_pk_bf16_f32 v39, v94, v95
    v_xor_b32 v125, 0, v152
    ds_write_b64 v125, v[32:33]
    v_xor_b32 v126, 16, v152
    ds_write_b64 v126, v[34:35]
    v_xor_b32 v125, 32, v152
    ds_write_b64 v125, v[36:37]
    v_xor_b32 v126, 48, v152
    ds_write_b64 v126, v[38:39]
    v_pk_mul_f32 v[96:97], v[96:97], v[122:123] op_sel_hi:[1,0]
    v_pk_mul_f32 v[98:99], v[98:99], v[122:123] op_sel_hi:[1,0]
    v_pk_mul_f32 v[100:101], v[100:101], v[122:123] op_sel_hi:[1,0]
    v_pk_mul_f32 v[102:103], v[102:103], v[122:123] op_sel_hi:[1,0]
    v_pk_mul_f32 v[104:105], v[104:105], v[122:123] op_sel_hi:[1,0]
    v_pk_mul_f32 v[106:107], v[106:107], v[122:123] op_sel_hi:[1,0]
    v_pk_mul_f32 v[108:109], v[108:109], v[122:123] op_sel_hi:[1,0]
    v_pk_mul_f32 v[110:111], v[110:111], v[122:123] op_sel_hi:[1,0]
    v_pk_fma_f32 v[96:97], v[16:17], v[124:125], v[96:97] op_sel_hi:[1,0,1]
    v_pk_fma_f32 v[98:99], v[18:19], v[124:125], v[98:99] op_sel_hi:[1,0,1]
    v_pk_fma_f32 v[100:101], v[20:21], v[124:125], v[100:101] op_sel_hi:[1,0,1]
    v_pk_fma_f32 v[102:103], v[22:23], v[124:125], v[102:103] op_sel_hi:[1,0,1]
    v_pk_fma_f32 v[104:105], v[24:25], v[124:125], v[104:105] op_sel_hi:[1,0,1]
    v_pk_fma_f32 v[106:107], v[26:27], v[124:125], v[106:107] op_sel_hi:[1,0,1]
    v_pk_fma_f32 v[108:109], v[28:29], v[124:125], v[108:109] op_sel_hi:[1,0,1]
    v_pk_fma_f32 v[110:111], v[30:31], v[124:125], v[110:111] op_sel_hi:[1,0,1]
    v_cvt_pk_bf16_f32 v40, v96, v97
    v_cvt_pk_bf16_f32 v41, v98, v99
    v_cvt_pk_bf16_f32 v42, v100, v101
    v_cvt_pk_bf16_f32 v43, v102, v103
    v_cvt_pk_bf16_f32 v44, v104, v105
    v_cvt_pk_bf16_f32 v45, v106, v107
    v_cvt_pk_bf16_f32 v46, v108, v109
    v_cvt_pk_bf16_f32 v47, v110, v111
    v_xor_b32 v125, 64, v152
    ds_write_b64 v125, v[40:41]
    v_xor_b32 v126, 80, v152
    ds_write_b64 v126, v[42:43]
    v_xor_b32 v125, 96, v152
    ds_write_b64 v125, v[44:45]
    v_xor_b32 v126, 112, v152
    s_waitcnt lgkmcnt(12)
    ds_write_b64 v126, v[46:47]
    ds_read_b128 v[48:51], v153 offset:0
    ds_read_b128 v[52:55], v153 offset:1024
    s_waitcnt lgkmcnt(12)
    ds_read_b128 v[56:59], v153 offset:2048
    ds_read_b128 v[60:63], v153 offset:3072
    s_mov_b32 s46, 0
    s_waitcnt lgkmcnt(3)
    buffer_store_dwordx4 v[48:51], v148, s[16:19], s46 offen offset:128 nt
    s_mov_b32 s46, 2048
    s_waitcnt lgkmcnt(2)
    buffer_store_dwordx4 v[52:55], v148, s[16:19], s46 offen offset:128 nt
    s_mov_b32 s46, 4096
    s_waitcnt lgkmcnt(1)
    buffer_store_dwordx4 v[56:59], v148, s[16:19], s46 offen offset:128 nt
    s_mov_b32 s46, 6144
    s_waitcnt lgkmcnt(0)
    buffer_store_dwordx4 v[60:63], v148, s[16:19], s46 offen offset:128 nt
    v_min_f32 v120, v156, v158
    v_min3_f32 v120, v120, v160, v162
    v_sub_f32 v128, v120, v156
    v_sub_f32 v129, v120, v158
    v_sub_f32 v130, v120, v160
    v_sub_f32 v131, v120, v162
    v_exp_f32 v128, v128
    v_exp_f32 v129, v129
    v_exp_f32 v130, v130
    v_exp_f32 v131, v131
    v_mul_f32 v121, v128, v157
    v_fmac_f32 v121, v129, v159
    v_fmac_f32 v121, v130, v161
    v_fmac_f32 v121, v131, v163
    v_mov_b32 v123, v121
    s_nop 1
    v_permlane32_swap_b32 v121, v123
    v_add_f32 v121, v121, v123
    v_mov_b32 v123, v121
    s_nop 1
    v_permlane16_swap_b32 v121, v123
    v_add_f32 v121, v121, v123
    v_rcp_f32 v121, v121
    s_nop 0
    v_mul_f32 v128, v128, v121
    v_mul_f32 v129, v129, v121
    v_mul_f32 v130, v130, v121
    v_mul_f32 v131, v131, v121
    v_mul_f32 v164, v164, v128
    v_mul_f32 v165, v165, v128
    v_mul_f32 v166, v166, v128
    v_mul_f32 v167, v167, v128
    v_fmac_f32 v164, v168, v129
    v_fmac_f32 v165, v169, v129
    v_fmac_f32 v166, v170, v129
    v_fmac_f32 v167, v171, v129
    v_fmac_f32 v164, v172, v130
    v_fmac_f32 v165, v173, v130
    v_fmac_f32 v166, v174, v130
    v_fmac_f32 v167, v175, v130
    v_fmac_f32 v164, v176, v131
    v_fmac_f32 v165, v177, v131
    v_fmac_f32 v166, v178, v131
    v_fmac_f32 v167, v179, v131
    v_cvt_pk_bf16_f32 v132, v164, v165
    v_cvt_pk_bf16_f32 v133, v166, v167
    buffer_store_dwordx2 v[132:133], v146, s[16:19], 0 offen offset:32 nt
    s_endpgm
L_rc_1:
    s_swappc_b64 s[32:33], s[34:35]
    s_branch L_rb_2
L_rc_11:
    s_swappc_b64 s[32:33], s[36:37]
    s_branch L_rb_12
L_rc_13:
    s_swappc_b64 s[32:33], s[34:35]
    s_branch L_rb_14
L_rc_15:
    s_swappc_b64 s[32:33], s[36:37]
    s_branch L_rb_16
L_rc_17:
    s_swappc_b64 s[32:33], s[34:35]
    s_branch L_rb_18
L_rc_19:
    s_swappc_b64 s[32:33], s[36:37]
    s_branch L_rb_20
L_rc_21:
    s_swappc_b64 s[32:33], s[34:35]
    s_branch L_rb_22
L_rc_23:
    s_swappc_b64 s[32:33], s[36:37]
    s_branch L_rb_24
L_rc_25:
    s_swappc_b64 s[32:33], s[34:35]
    s_branch L_rb_26
L_rc_27:
    s_swappc_b64 s[32:33], s[38:39]
    s_branch L_rb_28
L_rc_41:
    s_swappc_b64 s[32:33], s[36:37]
    s_branch L_rb_42
L_rc_43:
    s_swappc_b64 s[32:33], s[38:39]
    s_branch L_rb_44
L_rc_45:
    s_swappc_b64 s[32:33], s[34:35]
    s_branch L_rb_46
L_rc_47:
    s_swappc_b64 s[32:33], s[36:37]
    s_branch L_rb_48
L_rc_49:
    s_swappc_b64 s[32:33], s[38:39]
    s_branch L_rb_50
L_rc_51:
    s_swappc_b64 s[32:33], s[34:35]
    s_branch L_rb_52
L_rc_53:
    s_swappc_b64 s[32:33], s[36:37]
    s_branch L_rb_54
L_rc_55:
    s_swappc_b64 s[32:33], s[38:39]
    s_branch L_rb_56
L_rc_57:
    s_swappc_b64 s[32:33], s[34:35]
    s_branch L_rb_58
L_rc_59:
    s_swappc_b64 s[32:33], s[36:37]
    s_branch L_rb_60
L_rc_61:
    s_swappc_b64 s[32:33], s[34:35]
    s_branch L_rb_62
L_rc_63:
    s_swappc_b64 s[32:33], s[38:39]
    s_branch L_rb_64
L_rc_77:
    s_swappc_b64 s[32:33], s[36:37]
    s_branch L_rb_78
L_rc_79:
    s_swappc_b64 s[32:33], s[34:35]
    s_branch L_rb_80
L_rc_81:
    s_swappc_b64 s[32:33], s[38:39]
    s_branch L_rb_82
L_rc_83:
    s_swappc_b64 s[32:33], s[36:37]
    s_branch L_rb_84
L_rc_85:
    s_swappc_b64 s[32:33], s[34:35]
    s_branch L_rb_86
L_rc_87:
    s_swappc_b64 s[32:33], s[38:39]
    s_branch L_rb_88
L_rc_89:
    s_swappc_b64 s[32:33], s[36:37]
    s_branch L_rb_90
L_rc_91:
    s_swappc_b64 s[32:33], s[34:35]
    s_branch L_rb_92
L_rc_93:
    s_swappc_b64 s[32:33], s[38:39]
    s_branch L_rb_94
L_rc_95:
    s_swappc_b64 s[32:33], s[36:37]
    s_branch L_rb_96
L_rare_m0:
    s_nop 15
    s_nop 7
    v_max3_f32 v134, v0, v1, v2
    v_max3_f32 v134, v134, v3, v4
    v_max3_f32 v134, v134, v5, v6
    v_max3_f32 v134, v134, v7, v8
    v_max3_f32 v134, v134, v9, v10
    v_max3_f32 v134, v134, v11, v12
    v_max3_f32 v134, v134, v13, v14
    v_max_f32 v134, v134, v15
    v_mov_b32 v135, v134
    s_nop 1
    v_permlane32_swap_b32 v134, v135
    v_max_f32 v134, v134, v135
    v_max_f32 v134, 0, v134
    v_exp_f32 v132, -v134
    v_sub_f32 v32, v32, v134
    v_sub_f32 v33, v33, v134
    v_sub_f32 v34, v34, v134
    v_sub_f32 v35, v35, v134
    v_sub_f32 v36, v36, v134
    v_sub_f32 v37, v37, v134
    v_sub_f32 v38, v38, v134
    v_sub_f32 v39, v39, v134
    v_sub_f32 v40, v40, v134
    v_sub_f32 v41, v41, v134
    v_sub_f32 v42, v42, v134
    v_sub_f32 v43, v43, v134
    v_sub_f32 v44, v44, v134
    v_sub_f32 v45, v45, v134
    v_sub_f32 v46, v46, v134
    v_sub_f32 v47, v47, v134
    v_sub_f32 v0, v0, v134
    v_sub_f32 v1, v1, v134
    v_sub_f32 v2, v2, v134
    v_sub_f32 v3, v3, v134
    v_sub_f32 v4, v4, v134
    v_sub_f32 v5, v5, v134
    v_sub_f32 v6, v6, v134
    v_sub_f32 v7, v7, v134
    v_sub_f32 v8, v8, v134
    v_sub_f32 v9, v9, v134
    v_sub_f32 v10, v10, v134
    v_sub_f32 v11, v11, v134
    v_sub_f32 v12, v12, v134
    v_sub_f32 v13, v13, v134
    v_sub_f32 v14, v14, v134
    v_sub_f32 v15, v15, v134
    v_sub_f32 v16, v16, v134
    v_sub_f32 v17, v17, v134
    v_sub_f32 v18, v18, v134
    v_sub_f32 v19, v19, v134
    v_sub_f32 v20, v20, v134
    v_sub_f32 v21, v21, v134
    v_sub_f32 v22, v22, v134
    v_sub_f32 v23, v23, v134
    v_sub_f32 v24, v24, v134
    v_sub_f32 v25, v25, v134
    v_sub_f32 v26, v26, v134
    v_sub_f32 v27, v27, v134
    v_sub_f32 v28, v28, v134
    v_sub_f32 v29, v29, v134
    v_sub_f32 v30, v30, v134
    v_sub_f32 v31, v31, v134
    v_mul_f32 v140, v140, v132
    v_pk_mul_f32 v[48:49], v[48:49], v[132:133] op_sel_hi:[1,0]
    v_pk_mul_f32 v[50:51], v[50:51], v[132:133] op_sel_hi:[1,0]
    v_pk_mul_f32 v[52:53], v[52:53], v[132:133] op_sel_hi:[1,0]
    v_pk_mul_f32 v[54:55], v[54:55], v[132:133] op_sel_hi:[1,0]
    v_pk_mul_f32 v[56:57], v[56:57], v[132:133] op_sel_hi:[1,0]
    v_pk_mul_f32 v[58:59], v[58:59], v[132:133] op_sel_hi:[1,0]
    v_pk_mul_f32 v[60:61], v[60:61], v[132:133] op_sel_hi:[1,0]
    v_pk_mul_f32 v[62:63], v[62:63], v[132:133] op_sel_hi:[1,0]
    v_pk_mul_f32 v[64:65], v[64:65], v[132:133] op_sel_hi:[1,0]
    v_pk_mul_f32 v[66:67], v[66:67], v[132:133] op_sel_hi:[1,0]
    v_pk_mul_f32 v[68:69], v[68:69], v[132:133] op_sel_hi:[1,0]
    v_pk_mul_f32 v[70:71], v[70:71], v[132:133] op_sel_hi:[1,0]
    v_pk_mul_f32 v[72:73], v[72:73], v[132:133] op_sel_hi:[1,0]
    v_pk_mul_f32 v[74:75], v[74:75], v[132:133] op_sel_hi:[1,0]
    v_pk_mul_f32 v[76:77], v[76:77], v[132:133] op_sel_hi:[1,0]
    v_pk_mul_f32 v[78:79], v[78:79], v[132:133] op_sel_hi:[1,0]
    v_pk_mul_f32 v[80:81], v[80:81], v[132:133] op_sel_hi:[1,0]
    v_pk_mul_f32 v[82:83], v[82:83], v[132:133] op_sel_hi:[1,0]
    v_pk_mul_f32 v[84:85], v[84:85], v[132:133] op_sel_hi:[1,0]
    v_pk_mul_f32 v[86:87], v[86:87], v[132:133] op_sel_hi:[1,0]
    v_pk_mul_f32 v[88:89], v[88:89], v[132:133] op_sel_hi:[1,0]
    v_pk_mul_f32 v[90:91], v[90:91], v[132:133] op_sel_hi:[1,0]
    v_pk_mul_f32 v[92:93], v[92:93], v[132:133] op_sel_hi:[1,0]
    v_pk_mul_f32 v[94:95], v[94:95], v[132:133] op_sel_hi:[1,0]
    v_pk_mul_f32 v[96:97], v[96:97], v[132:133] op_sel_hi:[1,0]
    v_pk_mul_f32 v[98:99], v[98:99], v[132:133] op_sel_hi:[1,0]
    v_pk_mul_f32 v[100:101], v[100:101], v[132:133] op_sel_hi:[1,0]
    v_pk_mul_f32 v[102:103], v[102:103], v[132:133] op_sel_hi:[1,0]
    v_pk_mul_f32 v[104:105], v[104:105], v[132:133] op_sel_hi:[1,0]
    v_pk_mul_f32 v[106:107], v[106:107], v[132:133] op_sel_hi:[1,0]
    v_pk_mul_f32 v[108:109], v[108:109], v[132:133] op_sel_hi:[1,0]
    v_pk_mul_f32 v[110:111], v[110:111], v[132:133] op_sel_hi:[1,0]
    v_exp_f32 v132, v0
    v_exp_f32 v133, v1
    s_nop 0
    v_add_f32 v141, v132, v133
    v_cvt_pk_bf16_f32 v112, v132, v133
    v_exp_f32 v134, v2
    v_exp_f32 v135, v3
    v_add_f32 v141, v141, v134
    v_add_f32 v141, v141, v135
    v_cvt_pk_bf16_f32 v113, v134, v135
    v_exp_f32 v132, v4
    v_exp_f32 v133, v5
    v_add_f32 v141, v141, v132
    v_add_f32 v141, v141, v133
    v_cvt_pk_bf16_f32 v114, v132, v133
    v_exp_f32 v134, v6
    v_exp_f32 v135, v7
    v_add_f32 v141, v141, v134
    v_add_f32 v141, v141, v135
    v_cvt_pk_bf16_f32 v115, v134, v135
    v_exp_f32 v132, v8
    v_exp_f32 v133, v9
    v_add_f32 v141, v141, v132
    v_add_f32 v141, v141, v133
    v_cvt_pk_bf16_f32 v116, v132, v133
    v_exp_f32 v134, v10
    v_exp_f32 v135, v11
    v_add_f32 v141, v141, v134
    v_add_f32 v141, v141, v135
    v_cvt_pk_bf16_f32 v117, v134, v135
    v_exp_f32 v132, v12
    v_exp_f32 v133, v13
    v_add_f32 v141, v141, v132
    v_add_f32 v141, v141, v133
    v_cvt_pk_bf16_f32 v118, v132, v133
    v_exp_f32 v134, v14
    v_exp_f32 v135, v15
    v_add_f32 v141, v141, v134
    v_add_f32 v141, v141, v135
    v_cvt_pk_bf16_f32 v119, v134, v135
    s_nop 3
    s_setpc_b64 s[32:33]
L_rare_m1:
    s_nop 15
    s_nop 7
    v_max3_f32 v134, v16, v17, v18
    v_max3_f32 v134, v134, v19, v20
    v_max3_f32 v134, v134, v21, v22
    v_max3_f32 v134, v134, v23, v24
    v_max3_f32 v134, v134, v25, v26
    v_max3_f32 v134, v134, v27, v28
    v_max3_f32 v134, v134, v29, v30
    v_max_f32 v134, v134, v31
    v_mov_b32 v135, v134
    s_nop 1
    v_permlane32_swap_b32 v134, v135
    v_max_f32 v134, v134, v135
    v_max_f32 v134, 0, v134
    v_exp_f32 v132, -v134
    v_sub_f32 v32, v32, v134
    v_sub_f32 v33, v33, v134
    v_sub_f32 v34, v34, v134
    v_sub_f32 v35, v35, v134
    v_sub_f32 v36, v36, v134
    v_sub_f32 v37, v37, v134
    v_sub_f32 v38, v38, v134
    v_sub_f32 v39, v39, v134
    v_sub_f32 v40, v40, v134
    v_sub_f32 v41, v41, v134
    v_sub_f32 v42, v42, v134
    v_sub_f32 v43, v43, v134
    v_sub_f32 v44, v44, v134
    v_sub_f32 v45, v45, v134
    v_sub_f32 v46, v46, v134
    v_sub_f32 v47, v47, v134
    v_sub_f32 v16, v16, v134
    v_sub_f32 v17, v17, v134
    v_sub_f32 v18, v18, v134
    v_sub_f32 v19, v19, v134
    v_sub_f32 v20, v20, v134
    v_sub_f32 v21, v21, v134
    v_sub_f32 v22, v22, v134
    v_sub_f32 v23, v23, v134
    v_sub_f32 v24, v24, v134
    v_sub_f32 v25, v25, v134
    v_sub_f32 v26, v26, v134
    v_sub_f32 v27, v27, v134
    v_sub_f32 v28, v28, v134
    v_sub_f32 v29, v29, v134
    v_sub_f32 v30, v30, v134
    v_sub_f32 v31, v31, v134
    v_sub_f32 v0, v0, v134
    v_sub_f32 v1, v1, v134
    v_sub_f32 v2, v2, v134
    v_sub_f32 v3, v3, v134
    v_sub_f32 v4, v4, v134
    v_sub_f32 v5, v5, v134
    v_sub_f32 v6, v6, v134
    v_sub_f32 v7, v7, v134
    v_sub_f32 v8, v8, v134
    v_sub_f32 v9, v9, v134
    v_sub_f32 v10, v10, v134
    v_sub_f32 v11, v11, v134
    v_sub_f32 v12, v12, v134
    v_sub_f32 v13, v13, v134
    v_sub_f32 v14, v14, v134
    v_sub_f32 v15, v15, v134
    v_mul_f32 v140, v140, v132
    v_pk_mul_f32 v[48:49], v[48:49], v[132:133] op_sel_hi:[1,0]
    v_pk_mul_f32 v[50:51], v[50:51], v[132:133] op_sel_hi:[1,0]
    v_pk_mul_f32 v[52:53], v[52:53], v[132:133] op_sel_hi:[1,0]
    v_pk_mul_f32 v[54:55], v[54:55], v[132:133] op_sel_hi:[1,0]
    v_pk_mul_f32 v[56:57], v[56:57], v[132:133] op_sel_hi:[1,0]
    v_pk_mul_f32 v[58:59], v[58:59], v[132:133] op_sel_hi:[1,0]
    v_pk_mul_f32 v[60:61], v[60:61], v[132:133] op_sel_hi:[1,0]
    v_pk_mul_f32 v[62:63], v[62:63], v[132:133] op_sel_hi:[1,0]
    v_pk_mul_f32 v[64:65], v[64:65], v[132:133] op_sel_hi:[1,0]
    v_pk_mul_f32 v[66:67], v[66:67], v[132:133] op_sel_hi:[1,0]
    v_pk_mul_f32 v[68:69], v[68:69], v[132:133] op_sel_hi:[1,0]
    v_pk_mul_f32 v[70:71], v[70:71], v[132:133] op_sel_hi:[1,0]
    v_pk_mul_f32 v[72:73], v[72:73], v[132:133] op_sel_hi:[1,0]
    v_pk_mul_f32 v[74:75], v[74:75], v[132:133] op_sel_hi:[1,0]
    v_pk_mul_f32 v[76:77], v[76:77], v[132:133] op_sel_hi:[1,0]
    v_pk_mul_f32 v[78:79], v[78:79], v[132:133] op_sel_hi:[1,0]
    v_pk_mul_f32 v[80:81], v[80:81], v[132:133] op_sel_hi:[1,0]
    v_pk_mul_f32 v[82:83], v[82:83], v[132:133] op_sel_hi:[1,0]
    v_pk_mul_f32 v[84:85], v[84:85], v[132:133] op_sel_hi:[1,0]
    v_pk_mul_f32 v[86:87], v[86:87], v[132:133] op_sel_hi:[1,0]
    v_pk_mul_f32 v[88:89], v[88:89], v[132:133] op_sel_hi:[1,0]
    v_pk_mul_f32 v[90:91], v[90:91], v[132:133] op_sel_hi:[1,0]
    v_pk_mul_f32 v[92:93], v[92:93], v[132:133] op_sel_hi:[1,0]
    v_pk_mul_f32 v[94:95], v[94:95], v[132:133] op_sel_hi:[1,0]
    v_pk_mul_f32 v[96:97], v[96:97], v[132:133] op_sel_hi:[1,0]
    v_pk_mul_f32 v[98:99], v[98:99], v[132:133] op_sel_hi:[1,0]
    v_pk_mul_f32 v[100:101], v[100:101], v[132:133] op_sel_hi:[1,0]
    v_pk_mul_f32 v[102:103], v[102:103], v[132:133] op_sel_hi:[1,0]
    v_pk_mul_f32 v[104:105], v[104:105], v[132:133] op_sel_hi:[1,0]
    v_pk_mul_f32 v[106:107], v[106:107], v[132:133] op_sel_hi:[1,0]
    v_pk_mul_f32 v[108:109], v[108:109], v[132:133] op_sel_hi:[1,0]
    v_pk_mul_f32 v[110:111], v[110:111], v[132:133] op_sel_hi:[1,0]
    v_exp_f32 v132, v16
    v_exp_f32 v133, v17
    s_nop 0
    v_add_f32 v141, v132, v133
    v_cvt_pk_bf16_f32 v112, v132, v133
    v_exp_f32 v134, v18
    v_exp_f32 v135, v19
    v_add_f32 v141, v141, v134
    v_add_f32 v141, v141, v135
    v_cvt_pk_bf16_f32 v113, v134, v135
    v_exp_f32 v132, v20
    v_exp_f32 v133, v21
    v_add_f32 v141, v141, v132
    v_add_f32 v141, v141, v133
    v_cvt_pk_bf16_f32 v114, v132, v133
    v_exp_f32 v134, v22
    v_exp_f32 v135, v23
    v_add_f32 v141, v141, v134
    v_add_f32 v141, v141, v135
    v_cvt_pk_bf16_f32 v115, v134, v135
    v_exp_f32 v132, v24
    v_exp_f32 v133, v25
    v_add_f32 v141, v141, v132
    v_add_f32 v141, v141, v133
    v_cvt_pk_bf16_f32 v116, v132, v133
    v_exp_f32 v134, v26
    v_exp_f32 v135, v27
    v_add_f32 v141, v141, v134
    v_add_f32 v141, v141, v135
    v_cvt_pk_bf16_f32 v117, v134, v135
    v_exp_f32 v132, v28
    v_exp_f32 v133, v29
    v_add_f32 v141, v141, v132
    v_add_f32 v141, v141, v133
    v_cvt_pk_bf16_f32 v118, v132, v133
    v_exp_f32 v134, v30
    v_exp_f32 v135, v31
    v_add_f32 v141, v141, v134
    v_add_f32 v141, v141, v135
    v_cvt_pk_bf16_f32 v119, v134, v135
    s_nop 3
    s_setpc_b64 s[32:33]
L_rare_r:
    s_nop 15
    s_nop 7
    v_max3_f32 v154, v120, v121, v122
    v_max3_f32 v154, v154, v123, v124
    v_max3_f32 v154, v154, v125, v126
    v_max_f32 v154, v154, v127
    v_mov_b32 v155, v154
    s_nop 1
    v_permlane32_swap_b32 v154, v155
    v_max_f32 v154, v154, v155
    v_mov_b32 v155, v154
    s_nop 1
    v_permlane16_swap_b32 v154, v155
    v_max_f32 v154, v154, v155
    v_max_f32 v154, 0, v154
    v_exp_f32 v155, -v154
    v_sub_f32 v136, v136, v154
    v_sub_f32 v137, v137, v154
    v_sub_f32 v138, v138, v154
    v_sub_f32 v139, v139, v154
    v_sub_f32 v120, v120, v154
    v_sub_f32 v121, v121, v154
    v_sub_f32 v122, v122, v154
    v_sub_f32 v123, v123, v154
    v_sub_f32 v124, v124, v154
    v_sub_f32 v125, v125, v154
    v_sub_f32 v126, v126, v154
    v_sub_f32 v127, v127, v154
    v_mul_f32 v142, v142, v155
    v_accvgpr_read_b32 v154, a32
    v_mul_f32 v154, v154, v155
    v_accvgpr_write_b32 a32, v154
    v_accvgpr_read_b32 v154, a33
    v_mul_f32 v154, v154, v155
    v_accvgpr_write_b32 a33, v154
    v_accvgpr_read_b32 v154, a34
    v_mul_f32 v154, v154, v155
    v_accvgpr_write_b32 a34, v154
    v_accvgpr_read_b32 v154, a35
    v_mul_f32 v154, v154, v155
    v_accvgpr_write_b32 a35, v154
    v_accvgpr_read_b32 v154, a36
    v_mul_f32 v154, v154, v155
    v_accvgpr_write_b32 a36, v154
    v_accvgpr_read_b32 v154, a37
    v_mul_f32 v154, v154, v155
    v_accvgpr_write_b32 a37, v154
    v_accvgpr_read_b32 v154, a38
    v_mul_f32 v154, v154, v155
    v_accvgpr_write_b32 a38, v154
    v_accvgpr_read_b32 v154, a39
    v_mul_f32 v154, v154, v155
    v_accvgpr_write_b32 a39, v154
    v_accvgpr_read_b32 v154, a40
    v_mul_f32 v154, v154, v155
    v_accvgpr_write_b32 a40, v154
    v_accvgpr_read_b32 v154, a41
    v_mul_f32 v154, v154, v155
    v_accvgpr_write_b32 a41, v154
    v_accvgpr_read_b32 v154, a42
    v_mul_f32 v154, v154, v155
    v_accvgpr_write_b32 a42, v154
    v_accvgpr_read_b32 v154, a43
    v_mul_f32 v154, v154, v155
    v_accvgpr_write_b32 a43, v154
    v_accvgpr_read_b32 v154, a44
    v_mul_f32 v154, v154, v155
    v_accvgpr_write_b32 a44, v154
    v_accvgpr_read_b32 v154, a45
    v_mul_f32 v154, v154, v155
    v_accvgpr_write_b32 a45, v154
    v_accvgpr_read_b32 v154, a46
    v_mul_f32 v154, v154, v155
    v_accvgpr_write_b32 a46, v154
    v_accvgpr_read_b32 v154, a47
    v_mul_f32 v154, v154, v155
    v_accvgpr_write_b32 a47, v154
    v_accvgpr_read_b32 v154, a48
    v_mul_f32 v154, v154, v155
    v_accvgpr_write_b32 a48, v154
    v_accvgpr_read_b32 v154, a49
    v_mul_f32 v154, v154, v155
    v_accvgpr_write_b32 a49, v154
    v_accvgpr_read_b32 v154, a50
    v_mul_f32 v154, v154, v155
    v_accvgpr_write_b32 a50, v154
    v_accvgpr_read_b32 v154, a51
    v_mul_f32 v154, v154, v155
    v_accvgpr_write_b32 a51, v154
    v_accvgpr_read_b32 v154, a52
    v_mul_f32 v154, v154, v155
    v_accvgpr_write_b32 a52, v154
    v_accvgpr_read_b32 v154, a53
    v_mul_f32 v154, v154, v155
    v_accvgpr_write_b32 a53, v154
    v_accvgpr_read_b32 v154, a54
    v_mul_f32 v154, v154, v155
    v_accvgpr_write_b32 a54, v154
    v_accvgpr_read_b32 v154, a55
    v_mul_f32 v154, v154, v155
    v_accvgpr_write_b32 a55, v154
    v_accvgpr_read_b32 v154, a56
    v_mul_f32 v154, v154, v155
    v_accvgpr_write_b32 a56, v154
    v_accvgpr_read_b32 v154, a57
    v_mul_f32 v154, v154, v155
    v_accvgpr_write_b32 a57, v154
    v_accvgpr_read_b32 v154, a58
    v_mul_f32 v154, v154, v155
    v_accvgpr_write_b32 a58, v154
    v_accvgpr_read_b32 v154, a59
    v_mul_f32 v154, v154, v155
    v_accvgpr_write_b32 a59, v154
    v_accvgpr_read_b32 v154, a60
    v_mul_f32 v154, v154, v155
    v_accvgpr_write_b32 a60, v154
    v_accvgpr_read_b32 v154, a61
    v_mul_f32 v154, v154, v155
    v_accvgpr_write_b32 a61, v154
    v_accvgpr_read_b32 v154, a62
    v_mul_f32 v154, v154, v155
    v_accvgpr_write_b32 a62, v154
    v_accvgpr_read_b32 v154, a63
    v_mul_f32 v154, v154, v155
    v_accvgpr_write_b32 a63, v154
    v_exp_f32 v154, v120
    v_exp_f32 v155, v121
    s_nop 0
    v_add_f32 v143, v154, v155
    v_cvt_pk_bf16_f32 v128, v154, v155
    v_exp_f32 v154, v122
    v_exp_f32 v155, v123
    v_add_f32 v143, v143, v154
    v_add_f32 v143, v143, v155
    v_cvt_pk_bf16_f32 v129, v154, v155
    v_exp_f32 v154, v124
    v_exp_f32 v155, v125
    v_add_f32 v143, v143, v154
    v_add_f32 v143, v143, v155
    v_cvt_pk_bf16_f32 v130, v154, v155
    v_exp_f32 v154, v126
    v_exp_f32 v155, v127
    v_add_f32 v143, v143, v154
    v_add_f32 v143, v143, v155
    v_cvt_pk_bf16_f32 v131, v154, v155
    s_nop 3
    s_setpc_b64 s[32:33]
L_end:
    s_endpgm
.section .rodata,"a"
.p2align 6
.amdhsa_kernel standalone__gqa_softmax__near_ridge_kernel
  .amdhsa_next_free_vgpr 252
  .amdhsa_next_free_sgpr 96
  .amdhsa_accum_offset 188
  .amdhsa_group_segment_fixed_size 0
  .amdhsa_kernarg_size 48
  .amdhsa_user_sgpr_count 2
  .amdhsa_user_sgpr_kernarg_segment_ptr 1
  .amdhsa_system_sgpr_workgroup_id_x 1
.end_amdhsa_kernel
```
